```python
import torch

def _softmax(x, axis=-1):
    return torch.softmax(x, dim=axis)

def _gelu(x):
    return torch.nn.functional.gelu(x, approximate='tanh')

def _silu(x):
    return torch.nn.functional.silu(x)

def _sigmoid(x):
    return torch.sigmoid(x)

def _layernorm(x, axis=-1, eps=1e-05):
    m = x.mean(dim=axis, keepdim=True)
    v = x.var(dim=axis, keepdim=True, unbiased=False)
    return (x - m) / torch.sqrt(v + eps)

def _scatter_add(tgt, idx, src, axis=0):
    return tgt.clone().index_add_(axis, idx, src)

def _segment_sum(src, seg, n):
    out = torch.zeros((n,) + src.shape[1:], dtype=src.dtype)
    return out.index_add_(0, seg, src)

def _pad(x, pw):
    flat = tuple((v for pair in reversed(pw) for v in pair))
    return torch.nn.functional.pad(x, flat)
kernel_name = 'adaLN_cond__sliding_block__dense_activation_silu__prompt'

def setup_inputs():

    _w = lambda a: (lambda t: t.to(torch.bfloat16) if t.is_floating_point() else t)(torch.as_tensor(a))

    def _A_setup():
        B, S, D = (1, 2048, 512)
        return {'x': _w((lambda *s: torch.randn(*s, dtype=torch.bfloat16) * 0.05)(B, S, D)), 'wqkv': _w((lambda *s: torch.randn(*s, dtype=torch.bfloat16) * 0.05)(D, 3 * D)), 'wo': _w((lambda *s: torch.randn(*s, dtype=torch.bfloat16) * 0.05)(D, D))}
    _A_in = _A_setup()

    def _B_setup():
        B, S, D, F = (1, 2048, 512, 1376)
        return {'x': _w((lambda *s: torch.randn(*s, dtype=torch.bfloat16) * 0.05)(B, S, D)), 'w1': _w((lambda *s: torch.randn(*s, dtype=torch.bfloat16) * 3.2)(D, F) * D ** (-0.5)), 'w2': _w((lambda *s: torch.randn(*s, dtype=torch.bfloat16) * 0.4)(F, D) * F ** (-0.5))}
    _B_in = _B_setup()
    return {'A_x': _A_in['x'], 'A_wqkv': _A_in['wqkv'], 'A_wo': _A_in['wo'], 'B_x': _B_in['x'], 'B_w1': _B_in['w1'], 'B_w2': _B_in['w2'], 'c': _w((lambda *s: torch.randn(*s, dtype=torch.bfloat16) * 0.1)(1, 512) * 8.0), 'w_mod': _w((lambda *s: torch.randn(*s, dtype=torch.bfloat16) * 0.1)(512, 6 * 512) * 512 ** (-0.5) * 8.0)}

def reference(A_x, A_wqkv, A_wo, B_x, B_w1, B_w2, c, w_mod):

    def _A_ref(x, wqkv, wo):
        B, S, D = x.shape
        H = 32
        Dh = D // H
        W = 256
        qkv = (lambda x, *d: x.permute(*d))((x @ wqkv).reshape(B, S, 3, H, Dh), 2, 0, 3, 1, 4)
        q, k, v = (qkv[0], qkv[1], qkv[2])
        scores = torch.einsum('bhqd,bhkd->bhqk', q, k) * Dh ** (-0.5)
        idx = torch.arange(S)
        mask = (idx[:, None] - idx[None, :] >= 0) & (idx[:, None] - idx[None, :] < W)
        scores = torch.where(mask[None, None], scores, -1000000000.0)
        p = _softmax(scores, axis=-1)
        o = torch.einsum('bhqk,bhkd->bhqd', p, v)
        return (lambda x, *d: x.permute(*d))(o, 0, 2, 1, 3).reshape(B, S, D) @ wo

    def _B_ref(x, w1, w2):
        h = torch.einsum('bsd,df->bsf', x, w1)
        h = _silu(h)
        out = torch.einsum('bsf,fd->bsd', h, w2)
        return out
    x = A_x
    mod = (_silu(c) @ w_mod).reshape(c.shape[0], 6, 1, -1)
    sa, ca, ga, sb, cb, gb = (mod[:, 0].clone(), mod[:, 1].clone(), mod[:, 2].clone(), mod[:, 3].clone(), mod[:, 4].clone(), mod[:, 5].clone())
    h = _layernorm(x, axis=-1) * (1 + ca) + sa
    x = x + ga * _A_ref(h, A_wqkv, A_wo)
    h = _layernorm(x, axis=-1) * (1 + cb) + sb
    x = x + gb * _B_ref(h, B_w1, B_w2)
    return x
```

```asm
; @launch grid=(256,1,1) block=(256,1,1) lds=163840
.amdgcn_target "amdgcn-amd-amdhsa--gfx950"
.text
.globl adaLN_cond__sliding_block__dense_activation_silu__prompt_kernel
.p2align 8
.type adaLN_cond__sliding_block__dense_activation_silu__prompt_kernel,@function
adaLN_cond__sliding_block__dense_activation_silu__prompt_kernel:
    s_cmp_ge_u32 s2, 256
    s_cbranch_scc1 L_end
    s_load_dwordx16 s[4:19], s[0:1], 0
    s_load_dwordx4 s[20:23], s[0:1], 64
    s_load_dwordx2 s[24:25], s[0:1], 80
    v_mov_b32 v15, v0
    s_lshr_b32 s3, s2, 3
    s_lshl_b32 s3, s3, 11
    v_lshl_add_u32 v90, v15, 7, s3
    v_min_u32 v90, (L_code_end-adaLN_cond__sliding_block__dense_activation_silu__prompt_kernel-4), v90
    s_getpc_b64 s[72:73]
L_pc:
    s_sub_u32 s72, s72, (L_pc-adaLN_cond__sliding_block__dense_activation_silu__prompt_kernel)
    s_subb_u32 s73, s73, 0
    v_mov_b32 v91, s73
    v_add_co_u32 v90, vcc, s72, v90
    s_nop 1
    v_addc_co_u32 v91, vcc, 0, v91, vcc
    v_cmp_gt_u32 vcc, 16, v15
    s_cbranch_vccz L_touched
    s_mov_b64 exec, vcc
    global_load_dword v38, v[90:91], off
    s_mov_b64 exec, -1
L_touched:
    v_lshrrev_b32 v13, 6, v0
    v_and_b32 v12, 63, v0
    v_readfirstlane_b32 s58, v13
    s_and_b32 s3, s2, 7
    s_lshr_b32 s64, s2, 3
    s_lshr_b32 s65, s64, 4
    s_lshl_b32 s56, s3, 1
    s_add_u32 s56, s56, s65
    s_and_b32 s57, s64, 15
    s_lshl_b32 s63, s56, 4
    s_add_u32 s63, s63, s57
    s_lshl_b32 s27, s56, 2
    s_add_u32 s27, s27, s58
    s_lshl_b32 s87, s58, 12
    s_lshl_b32 s92, s64, 2
    s_add_u32 s92, s92, s58
    s_mul_i32 s64, s56, 196608
    s_and_b32 s3, s57, 1
    s_lshl_b32 s3, s3, 10
    s_add_u32 s64, s64, s3
    s_lshr_b32 s3, s57, 1
    s_lshl_b32 s3, s3, 7
    s_add_u32 s64, s64, s3
    s_lshl_b32 s3, s58, 5
    s_add_u32 s64, s64, s3
    s_lshl_b32 s65, s56, 6
    v_lshlrev_b32 v1, 4, v12
    v_lshrrev_b32 v92, 1, v12
    v_mul_u32_u24 v84, 6144, v92
    v_and_b32 v93, 1, v12
    v_lshl_add_u32 v84, v93, 4, v84
    v_lshlrev_b32 v85, 1, v92
    s_lshl_b32 s66, s63, 3
    s_lshl_b32 s3, s58, 1
    s_add_u32 s66, s66, s3
    s_lshl_b32 s67, s66, 10
    s_mov_b32 s38, 3145728
    s_mov_b32 s39, 0x20000
    s_mov_b32 s50, 24117248
    s_mov_b32 s51, 0x20000
    s_mov_b32 s42, 1024
    s_mov_b32 s43, 0x20000
    s_mov_b32 s30, 2097152
    s_mov_b32 s31, 0x20000
    s_waitcnt lgkmcnt(0)
    s_mov_b32 s36, s18
    s_and_b32 s37, s19, 0xffff
    buffer_load_dwordx4 v[32:35], v84, s[36:39], s64 offen
    s_mov_b32 s48, s24
    s_and_b32 s49, s25, 0xffff
    s_mov_b64 exec, 1
    buffer_load_dword v60, v1, s[48:51], 0 offen sc1
    s_mov_b64 exec, -1
    s_mov_b32 s40, s16
    s_and_b32 s41, s17, 0xffff
    buffer_load_ushort v36, v85, s[40:43], s65 offen
    s_mov_b32 s28, s4
    s_and_b32 s29, s5, 0xffff
    buffer_load_dwordx4 v[40:43], v1, s[28:31], s67 offen
    buffer_load_dwordx4 v[44:47], v1, s[28:31], s67 offen offset:1024
    s_lshl_b32 s96, s58, 8
    s_add_u32 s96, s96, s63
    s_and_b32 s3, s96, 31
    s_mul_i32 s93, s3, 49152
    s_lshl_b32 s94, s3, 10
    s_lshr_b32 s3, s96, 5
    s_lshl_b32 s97, s3, 7
    s_add_u32 s93, s93, s97
    s_lshl_b32 s3, s3, 16
    s_add_u32 s94, s94, s3
    s_add_u32 s94, s94, 22020096
    s_lshl_b32 s96, s96, 2
    s_add_u32 s96, s96, 12288
    s_cmp_eq_u32 s58, 3
    s_cselect_b32 s93, 0x7f000000, s93
    s_cselect_b32 s94, 0x7f000000, s94
    s_cselect_b32 s96, 0x7f000000, s96
    v_lshrrev_b32 v5, 3, v12
    v_mul_u32_u24 v5, 2944, v5
    v_add_u32 v5, v5, v1
    s_mov_b32 s34, 1572864
    s_mov_b32 s35, 0x20000
    s_mov_b32 s32, s6
    s_and_b32 s33, s7, 0xffff
    s_and_b32 s22, s2, 7
    s_lshl_b32 s3, s58, 11
    s_add_u32 m0, s3, 114688
    s_nop 0
    buffer_load_dwordx4 v5, s[32:35], s93 offen lds
    s_add_u32 m0, m0, 1024
    s_add_u32 s93, s93, 24576
    buffer_load_dwordx4 v5, s[32:35], s93 offen lds
    s_lshl_b32 s70, s27, 15
    s_lshl_b32 s3, s57, 11
    s_add_u32 s68, s70, s3
    s_lshl_b32 s3, s57, 6
    s_add_u32 s70, s70, s3
    s_lshl_b32 s81, s58, 10
    s_lshl_b32 s80, s57, 15
    s_add_u32 s80, s80, s81
    s_add_u32 s80, s80, 22020096
    s_lshl_b32 s69, s27, 6
    s_add_u32 s69, s69, 8192
    v_lshrrev_b32 v92, 2, v12
    v_and_b32 v96, 3, v12
    v_lshlrev_b32 v94, 4, v96
    v_lshl_add_u32 v89, v92, 10, v94
    v_lshlrev_b32 v88, 7, v12
    v_mul_u32_u24 v87, 3072, v92
    v_add_u32 v87, v87, v94
    s_lshl_b32 s72, s58, 8
    s_add_u32 s72, s72, s63
    s_cmp_ge_u32 s72, 256
    s_cselect_b32 s3, 256, 0
    s_mov_b32 s90, 17825792
    s_cmov_b32 s90, 19922944
    s_mov_b32 s91, 32768
    s_cmov_b32 s91, 88064
    s_sub_u32 s72, s72, s3
    s_lshr_b32 s3, s72, 3
    s_lshl_b32 s71, s3, 14
    s_lshl_b32 s3, s3, 10
    s_add_u32 s90, s90, s3
    s_and_b32 s3, s72, 7
    s_lshl_b32 s3, s3, 7
    s_add_u32 s71, s71, s3
    s_lshr_b32 s3, s3, 6
    s_mul_i32 s3, s3, s91
    s_add_u32 s90, s90, s3
    s_cmp_ge_u32 s72, 688
    s_cselect_b32 s71, 0x7f000000, s71
    s_cselect_b32 s90, 0x7f000000, s90
    s_add_u32 s91, s91, s90
    v_lshrrev_b32 v6, 3, v12
    v_and_b32 v86, 0x70, v1
    v_lshl_add_u32 v6, v6, 10, v86
    s_getreg_b32 s62, hwreg(HW_REG_XCC_ID, 0, 4)
    s_mov_b32 s26, 0xffff0000
    s_mov_b32 s46, 2097152
    s_mov_b32 s47, 0x20000
    s_mov_b32 s55, 0x20000
    s_mov_b32 s44, s20
    s_and_b32 s45, s21, 0xffff
    s_cmp_eq_u32 s58, 0
    s_cselect_b32 s52, s8, s14
    s_cselect_b32 s53, s9, s15
    s_mov_b32 s54, 1409024
    s_cmov_b32 s54, 524288
    s_and_b32 s53, s53, 0xffff
    s_and_b32 s13, s13, 0xffff
    s_mov_b32 s14, 1409024
    s_mov_b32 s15, 0x20000
    s_add_u32 m0, s87, 100352
    s_nop 0
    buffer_load_dwordx4 v89, s[28:31], s70 offen lds
    s_add_u32 m0, s87, 101376
    s_add_u32 s70, s70, 16384
    buffer_load_dwordx4 v89, s[28:31], s70 offen lds
    s_mov_b64 exec, 0xffff
    buffer_load_dword v37, v88, s[44:47], s68 offen sc1
    s_mov_b64 exec, 1
    buffer_load_dword v39, v88, s[48:51], s69 offen sc1
    s_mov_b64 exec, -1
    s_mov_b32 s61, 0x400000
    s_lshr_b32 s76, s57, 3
    s_lshl_b32 s76, s76, 1
    s_lshr_b32 s3, s58, 1
    s_add_u32 s76, s76, s3
    s_and_b32 s77, s57, 7
    s_lshl_b32 s77, s77, 6
    s_and_b32 s3, s58, 1
    s_lshl_b32 s3, s3, 5
    s_add_u32 s77, s77, s3
    v_and_b32 v98, 15, v12
    v_lshrrev_b32 v97, 2, v98
    v_lshlrev_b32 v97, 6, v97
    v_lshl_add_u32 v97, v96, 3, v97
    v_bfe_u32 v98, v12, 4, 1
    v_lshl_add_u32 v97, v98, 5, v97
    v_lshrrev_b32 v99, 5, v12
    v_and_b32 v100, 0xc0, v97
    v_add_u32 v2, v97, v100
    v_lshl_add_u32 v2, v99, 10, v2
    s_lshl_b32 s3, s58, 11
    s_add_u32 s3, s3, 114688
    v_add_u32 v2, s3, v2
    v_add_u32 v3, 0x10000, v1
    v_lshl_add_u32 v91, v99, 9, v97
    v_lshl_add_u32 v90, v99, 8, v97
    v_and_b32 v100, 0x1c0, v90
    v_mul_u32_u24 v102, 3, v100
    v_and_b32 v101, 63, v90
    v_add_u32 v102, v102, v101
    v_accvgpr_write_b32 a255, v102
    v_lshl_add_u32 v90, v100, 1, v101
    s_add_u32 s3, s87, 98304
    v_add_u32 v90, s3, v90
    v_lshlrev_b32 v92, 10, v98
    v_lshl_add_u32 v92, v99, 4, v92
    v_and_b32 v100, 16, v1
    v_lshl_add_u32 v92, v100, 1, v92
    v_lshlrev_b32 v95, 2, v96
    v_lshl_add_u32 v95, v99, 1, v95
    v_add_u32 v95, v95, v98
    s_and_b32 s3, s58, 1
    v_cvt_f32_u32 v86, s3
    s_lshl_b32 s3, s3, 5
    s_lshr_b32 s73, s58, 1
    s_lshl_b32 s73, s73, 4
    s_add_u32 s3, s3, s73
    v_add_lshl_u32 v95, v95, s3, 2
    v_add_u32 v95, 152320, v95
    v_lshlrev_b32 v94, 5, v99
    v_add_u32 v94, 152320, v94
    s_and_b32 s3, s57, 1
    s_lshl_b32 s64, s3, 5
    s_lshr_b32 s3, s57, 1
    s_lshl_b32 s3, s3, 2
    s_add_u32 s64, s64, s3
    s_add_u32 s64, s64, s58
    s_lshl_b32 s64, s64, 5
    s_add_u32 s64, s64, s56
    s_lshl_b32 s64, s64, 6
    s_add_u32 s64, s64, 131072
    s_lshl_b32 s73, s63, 2
    s_add_u32 s73, s73, 5120
    s_cmp_eq_u32 s58, 0
    s_cselect_b32 s73, s73, 0x7f000000
    s_lshl_b32 s66, s66, 4
    s_add_u32 s66, s66, 32768
    s_waitcnt vmcnt(8)
    v_readfirstlane_b32 s59, v60
    v_lshlrev_b32 v96, 16, v36
    v_mul_f32 v97, 0xbfb8aa3b, v96
    v_exp_f32 v97, v97
    s_nop 0
    v_add_f32 v97, 1.0, v97
    v_rcp_f32 v97, v97
    s_nop 0
    v_mul_f32 v96, v96, v97
    v_cvt_pk_bf16_f32 v96, v96, v96
    v_and_b32 v96, s26, v96
    s_add_u32 s59, s59, 2654435760
    s_and_b32 s59, s59, 0xfffffff0
    s_or_b32 s3, s59, s62
    v_lshlrev_b32 v100, 16, v32
    v_and_b32 v101, s26, v32
    v_lshlrev_b32 v102, 16, v33
    v_and_b32 v103, s26, v33
    v_lshlrev_b32 v104, 16, v34
    v_and_b32 v105, s26, v34
    v_lshlrev_b32 v106, 16, v35
    v_and_b32 v107, s26, v35
    v_mov_b32 v14, s3
    v_mov_b32 v13, 0
    v_mov_b32 v109, s59
    v_mov_b32 v111, s59
    v_mul_f32 v100, v96, v100
    v_mul_f32 v101, v96, v101
    v_mul_f32 v102, v96, v102
    v_mul_f32 v103, v96, v103
    v_mul_f32 v104, v96, v104
    v_mul_f32 v105, v96, v105
    v_mul_f32 v106, v96, v106
    v_mul_f32 v107, v96, v107
    s_mov_b32 s3, 0x3f803f80
    v_permlane32_swap_b32 v100, v104
    v_permlane32_swap_b32 v101, v105
    v_permlane32_swap_b32 v102, v106
    v_permlane32_swap_b32 v103, v107
    v_add_f32 v100, v100, v104
    v_add_f32 v101, v101, v105
    v_add_f32 v102, v102, v106
    v_add_f32 v103, v103, v107
    s_nop 0
    v_permlane16_swap_b32 v100, v102
    v_permlane16_swap_b32 v101, v103
    v_add_f32 v100, v100, v102
    v_add_f32 v101, v101, v103
    s_nop 0
    v_add_f32_dpp v100, v100, v100 row_ror:8 row_mask:0xf bank_mask:0xf
    v_add_f32_dpp v101, v101, v101 row_ror:8 row_mask:0xf bank_mask:0xf
    s_nop 0
    v_add_f32_dpp v100, v100, v100 row_ror:4 row_mask:0xf bank_mask:0xf
    v_add_f32_dpp v101, v101, v101 row_ror:4 row_mask:0xf bank_mask:0xf
    s_nop 0
    v_add_f32_dpp v100, v100, v100 row_ror:2 row_mask:0xf bank_mask:0xf
    v_add_f32_dpp v101, v101, v101 row_ror:2 row_mask:0xf bank_mask:0xf
    v_mov_b32 v103, v111
    v_mov_b32 v102, v101
    v_mov_b32 v101, v111
    s_mov_b32 exec_lo, 0x00030003
    s_mov_b32 exec_hi, 0x00030003
    buffer_store_dwordx4 v[100:103], v92, s[48:51], s64 offen sc1
    s_mov_b64 exec, 1
    buffer_store_dword v14, v13, s[48:51], s73 offen sc1
    s_mov_b64 exec, -1
    s_waitcnt vmcnt(8)
    v_dot2_f32_bf16 v112, v40, s3, 0
    v_dot2_f32_bf16 v113, v40, v40, 0
    v_dot2_f32_bf16 v114, v44, s3, 0
    v_dot2_f32_bf16 v115, v44, v44, 0
    v_dot2_f32_bf16 v112, v41, s3, v112
    v_dot2_f32_bf16 v113, v41, v41, v113
    v_dot2_f32_bf16 v114, v45, s3, v114
    v_dot2_f32_bf16 v115, v45, v45, v115
    v_dot2_f32_bf16 v112, v42, s3, v112
    v_dot2_f32_bf16 v113, v42, v42, v113
    v_dot2_f32_bf16 v114, v46, s3, v114
    v_dot2_f32_bf16 v115, v46, v46, v115
    v_dot2_f32_bf16 v112, v43, s3, v112
    v_dot2_f32_bf16 v113, v43, v43, v113
    v_dot2_f32_bf16 v114, v47, s3, v114
    v_dot2_f32_bf16 v115, v47, v47, v115
    v_lshrrev_b32 v96, 1, v12
    s_nop 0
    v_permlane32_swap_b32 v112, v114
    v_permlane32_swap_b32 v113, v115
    v_add_f32 v112, v112, v114
    v_add_f32 v113, v113, v115
    s_nop 1
    v_permlane16_swap_b32 v112, v113
    v_add_f32 v108, v112, v113
    s_nop 1
    v_add_f32_dpp v108, v108, v108 row_ror:8 row_mask:0xf bank_mask:0xf
    s_nop 1
    v_add_f32_dpp v108, v108, v108 row_ror:4 row_mask:0xf bank_mask:0xf
    s_nop 1
    v_add_f32_dpp v108, v108, v108 row_ror:2 row_mask:0xf bank_mask:0xf
    s_nop 1
    v_add_f32_dpp v108, v108, v108 row_ror:1 row_mask:0xf bank_mask:0xf
    v_mov_b32 v110, v108
    s_nop 1
    v_permlane16_swap_b32 v108, v110
    v_mul_f32 v108, 0x3b000000, v108
    v_mul_f32 v105, v108, v108
    s_mov_b32 s75, 0x3b000000
    v_fma_f32 v110, v110, s75, -v105
    v_max_f32 v110, 0, v110
    v_cvt_pk_bf16_f32 v108, v108, v108
    v_and_b32 v108, s26, v108
    v_cvt_pk_bf16_f32 v110, v110, v110
    v_and_b32 v110, s26, v110
    v_add_f32 v110, 0x3727c5ac, v110
    v_cvt_pk_bf16_f32 v110, v110, v110
    v_and_b32 v110, s26, v110
    v_sqrt_f32 v110, v110
    s_nop 0
    v_cvt_pk_bf16_f32 v110, v110, v110
    v_and_b32 v110, s26, v110
    v_rcp_f32 v110, v110
    s_mov_b32 exec_lo, 1
    s_mov_b32 exec_hi, 1
    buffer_store_dwordx4 v[108:111], v96, s[48:51], s66 offen sc1
    s_mov_b64 exec, -1
    s_waitcnt vmcnt(7)
    ds_read_b64_tr_b16 v[76:77], v2 offset:0
    ds_read_b64_tr_b16 v[78:79], v2 offset:512
    ds_read_b64_tr_b16 v[80:81], v2 offset:64
    ds_read_b64_tr_b16 v[82:83], v2 offset:576
    s_add_u32 s93, s94, 32768
    s_waitcnt lgkmcnt(2)
    buffer_store_dwordx4 v[76:79], v1, s[48:51], s94 offen sc1
    s_waitcnt lgkmcnt(0)
    buffer_store_dwordx4 v[80:83], v1, s[48:51], s93 offen sc1
    s_add_u32 m0, s87, 98304
    s_nop 0
    buffer_load_dwordx4 v6, s[52:55], s71 offen lds
    s_add_u32 m0, s87, 99328
    s_add_u32 s71, s71, 8192
    buffer_load_dwordx4 v6, s[52:55], s71 offen lds
    s_and_b32 s73, s63, 7
    s_lshl_b32 s74, s73, 2
    s_add_u32 s74, s74, s58
    s_mul_i32 s74, s74, 98304
    s_lshr_b32 s3, s63, 3
    s_lshl_b32 s3, s3, 7
    s_add_u32 s74, s74, s3
    s_add_u32 s74, s74, 2048
    s_lshl_b32 s73, s73, 7
    v_lshrrev_b32 v103, 3, v12
    v_mul_u32_u24 v103, 6016, v103
    v_add_u32 v103, v103, v1
    s_lshl_b32 s3, s58, 11
    s_add_u32 m0, s3, 154624
    s_nop 0
    buffer_load_dwordx4 v103, s[36:39], s74 offen lds
    s_add_u32 s74, s74, 49152
    v_lshrrev_b32 v103, 3, v12
    v_mul_u32_u24 v103, 6016, v103
    v_add_u32 v103, v103, v1
    s_lshl_b32 s3, s58, 11
    s_add_u32 m0, s3, 155648
    s_nop 0
    buffer_load_dwordx4 v103, s[36:39], s74 offen lds
    v_and_b32 v103, 62, v12
    buffer_load_ushort a250, v103, s[40:43], s73 offen
    buffer_load_ushort a251, v103, s[40:43], s73 offen offset:64
    v_and_b32 v8, 31, v12
    v_lshrrev_b32 v11, 5, v12
    v_lshlrev_b32 v11, 2, v11
    v_sub_u32 v8, v8, v11
    v_mov_b32 v11, 0xf149f2ca
    v_cmp_le_i32 vcc, 0, v8
    v_cmp_le_i32 s[94:95], 1, v8
    s_nop 0
    v_cndmask_b32_e64 v16, 0, v11, vcc
    v_cndmask_b32_e64 v17, 0, v11, s[94:95]
    v_cmp_le_i32 vcc, 2, v8
    v_cmp_le_i32 s[94:95], 3, v8
    s_nop 0
    v_cndmask_b32_e64 v18, 0, v11, vcc
    v_cndmask_b32_e64 v19, 0, v11, s[94:95]
    v_cmp_le_i32 vcc, 8, v8
    v_cmp_le_i32 s[94:95], 9, v8
    s_nop 0
    v_cndmask_b32_e64 v20, 0, v11, vcc
    v_cndmask_b32_e64 v21, 0, v11, s[94:95]
    v_cmp_le_i32 vcc, 10, v8
    v_cmp_le_i32 s[94:95], 11, v8
    s_nop 0
    v_cndmask_b32_e64 v22, 0, v11, vcc
    v_cndmask_b32_e64 v23, 0, v11, s[94:95]
    v_cmp_le_i32 vcc, 16, v8
    v_cmp_le_i32 s[94:95], 17, v8
    s_nop 0
    v_cndmask_b32_e64 v24, 0, v11, vcc
    v_cndmask_b32_e64 v25, 0, v11, s[94:95]
    v_cmp_le_i32 vcc, 18, v8
    v_cmp_le_i32 s[94:95], 19, v8
    s_nop 0
    v_cndmask_b32_e64 v26, 0, v11, vcc
    v_cndmask_b32_e64 v27, 0, v11, s[94:95]
    v_cmp_le_i32 vcc, 24, v8
    v_cmp_le_i32 s[94:95], 25, v8
    s_nop 0
    v_cndmask_b32_e64 v28, 0, v11, vcc
    v_cndmask_b32_e64 v29, 0, v11, s[94:95]
    v_cmp_le_i32 vcc, 26, v8
    v_cmp_le_i32 s[94:95], 27, v8
    s_nop 0
    v_cndmask_b32_e64 v30, 0, v11, vcc
    v_cndmask_b32_e64 v31, 0, v11, s[94:95]
    s_cmp_ge_u32 s57, 11
    s_cselect_b32 s93, 8, 12
    v_add_u32 v8, 0, v12
    v_mul_u32_u24 v9, 0x1556, v8
    v_lshrrev_b32 v9, 16, v9
    v_mul_u32_u24 v10, 12, v9
    v_sub_u32 v8, v8, v10
    v_cmp_gt_u32 vcc, s93, v8
    v_lshlrev_b32 v8, 4, v8
    v_mul_u32_u24 v9, 2752, v9
    v_add_u32 v8, v8, v9
    v_mov_b32 v10, 0x7f000000
    v_cndmask_b32 v8, v10, v8, vcc
    v_accvgpr_write_b32 a240, v8
    v_add_u32 v8, 64, v12
    v_mul_u32_u24 v9, 0x1556, v8
    v_lshrrev_b32 v9, 16, v9
    v_mul_u32_u24 v10, 12, v9
    v_sub_u32 v8, v8, v10
    v_cmp_gt_u32 vcc, s93, v8
    v_lshlrev_b32 v8, 4, v8
    v_mul_u32_u24 v9, 2752, v9
    v_add_u32 v8, v8, v9
    v_mov_b32 v10, 0x7f000000
    v_mov_b32 v14, s59
    s_waitcnt vmcnt(6)
    s_mov_b64 exec, 1
    buffer_store_dword v14, v13, s[48:51], s96 offen sc1
    s_mov_b64 exec, -1
    v_and_b32 v97, 31, v12
    v_lshlrev_b32 v85, 4, v97
    v_lshlrev_b32 v97, 6, v97
    v_lshl_add_u32 v97, v99, 4, v97
    s_add_u32 s3, s87, 100352
    v_add_u32 v97, s3, v97
    ds_read_b128 v[48:51], v97
    ds_read_b128 v[52:55], v97 offset:32
    s_waitcnt lgkmcnt(0)
    v_lshlrev_b32 v112, 16, v48
    v_and_b32 v113, s26, v48
    v_lshlrev_b32 v114, 16, v49
    v_and_b32 v115, s26, v49
    v_lshlrev_b32 v116, 16, v50
    v_and_b32 v117, s26, v50
    v_lshlrev_b32 v118, 16, v51
    v_and_b32 v119, s26, v51
    v_lshlrev_b32 v120, 16, v52
    v_and_b32 v121, s26, v52
    v_lshlrev_b32 v122, 16, v53
    v_and_b32 v123, s26, v53
    v_lshlrev_b32 v124, 16, v54
    v_and_b32 v125, s26, v54
    v_lshlrev_b32 v126, 16, v55
    v_and_b32 v127, s26, v55
    s_and_b32 s3, s58, 1
    s_lshl_b32 s64, s3, 5
    s_lshl_b32 s3, s57, 1
    s_add_u32 s64, s64, s3
    s_lshr_b32 s3, s58, 1
    s_add_u32 s64, s64, s3
    s_lshl_b32 s64, s64, 11
    s_add_u32 s64, s64, 131072
    s_lshl_b32 s65, s27, 9
    s_add_u32 s65, s65, 32768
    v_and_b32 v93, 15, v12
    v_lshlrev_b32 v93, 2, v93
    s_lshl_b32 s66, s56, 6
    s_add_u32 s66, s66, 5120
    s_lshl_b32 s67, s63, 2
    s_add_u32 s67, s67, 4096
    s_cmp_eq_u32 s58, 0
    s_cselect_b32 s67, s67, 0x7f000000
    s_lshl_b32 s70, s57, 2
    s_add_u32 s70, s70, s69
    s_lshr_b32 s72, s57, 1
    s_lshl_b32 s72, s72, 7
    s_add_u32 s72, s72, 12288
    v_and_b32 v84, 31, v12
    v_lshlrev_b32 v84, 2, v84
    v_lshl_add_u32 v89, v99, 10, v84
    v_cndmask_b32 v8, v10, v8, vcc
    v_accvgpr_write_b32 a241, v8
    v_add_u32 v8, 128, v12
    v_mul_u32_u24 v9, 0x1556, v8
    v_lshrrev_b32 v9, 16, v9
    v_mul_u32_u24 v10, 12, v9
    v_sub_u32 v8, v8, v10
    v_cmp_gt_u32 vcc, s93, v8
    v_lshlrev_b32 v8, 4, v8
    v_mul_u32_u24 v9, 2752, v9
    v_add_u32 v8, v8, v9
    v_mov_b32 v10, 0x7f000000
    v_cndmask_b32 v8, v10, v8, vcc
    v_accvgpr_write_b32 a242, v8
L_poll_1:
    buffer_load_dwordx4 v[96:99], v1, s[48:51], s64 offen sc1
    buffer_load_dwordx4 v[100:103], v1, s[48:51], s64 offen offset:1024 sc1
    buffer_load_dwordx4 v[104:107], v85, s[48:51], s65 offen sc1
    buffer_load_dword v108, v93, s[48:51], s66 offen sc1
    s_waitcnt vmcnt(0)
    v_and_b32 v109, -16, v108
    v_xor_b32 v109, s59, v109
    v_bitop3_b32 v109, v109, v97, s59 bitop3:0xf6
    v_bitop3_b32 v109, v109, v99, s59 bitop3:0xf6
    v_bitop3_b32 v109, v109, v101, s59 bitop3:0xf6
    v_bitop3_b32 v109, v109, v103, s59 bitop3:0xf6
    v_bitop3_b32 v109, v109, v105, s59 bitop3:0xf6
    v_bitop3_b32 v109, v109, v107, s59 bitop3:0xf6
    v_cmp_ne_u32 vcc, 0, v109
    s_cbranch_vccz L_polled_2
    s_cmp_eq_u32 s61, 0
    s_cbranch_scc1 L_polled_2
    s_sub_u32 s61, s61, 1
    s_sleep 1
    s_branch L_poll_1
L_polled_2:
    v_permlane32_swap_b32 v96, v100
    v_permlane32_swap_b32 v98, v102
    v_and_b32 v108, 15, v108
    v_add_f32 v96, v96, v100
    v_add_f32 v98, v98, v102
    v_cmp_ne_u32 vcc, s62, v108
    v_mul_f32 v104, v104, v106
    v_permlane16_swap_b32 v96, v98
    v_add_f32 v96, v96, v98
    s_cmp_eq_u64 vcc, 0
    s_cselect_b32 s60, 1, 0
    v_fma_f32 v112, v112, v106, -v104
    v_fma_f32 v113, v113, v106, -v104
    v_add_f32_dpp v96, v96, v96 row_ror:8 row_mask:0xf bank_mask:0xf
    v_fma_f32 v114, v114, v106, -v104
    v_fma_f32 v115, v115, v106, -v104
    v_add_f32_dpp v96, v96, v96 row_ror:4 row_mask:0xf bank_mask:0xf
    v_cvt_pk_bf16_f32 v96, v96, v96
    v_and_b32 v96, s26, v96
    v_add_f32 v96, v96, v86
    v_cvt_pk_bf16_f32 v96, v96, v96
    v_and_b32 v96, s26, v96
    ds_write_b32 v95, v96
    s_add_u32 s8, s48, 3145728
    s_addc_u32 s9, s49, 0
    s_cmp_lg_u32 s60, 0
    s_cselect_b32 s8, s44, s8
    s_cselect_b32 s9, s45, s9
    s_mov_b32 s78, 5242880
    s_cmov_b32 s78, 11534336
    s_mov_b32 s96, 32768
    s_cmov_b32 s96, 88064
    s_and_b32 s9, s9, 0xffff
    s_mov_b32 s10, 2097152
    s_mov_b32 s11, 0x20000
    s_waitcnt lgkmcnt(0)
    s_barrier
    ds_read_b128 v[32:35], v94 offset:128
    ds_read_b128 v[48:51], v94 offset:0
    ds_read_b128 v[36:39], v94 offset:144
    ds_read_b128 v[52:55], v94 offset:16
    ds_read_b128 v[40:43], v94 offset:192
    ds_read_b128 v[56:59], v94 offset:64
    ds_read_b128 v[44:47], v94 offset:208
    ds_read_b128 v[60:63], v94 offset:80
    v_fma_f32 v116, v116, v106, -v104
    v_fma_f32 v117, v117, v106, -v104
    v_fma_f32 v118, v118, v106, -v104
    v_fma_f32 v119, v119, v106, -v104
    v_fma_f32 v120, v120, v106, -v104
    v_fma_f32 v121, v121, v106, -v104
    v_fma_f32 v122, v122, v106, -v104
    v_fma_f32 v123, v123, v106, -v104
    v_fma_f32 v124, v124, v106, -v104
    v_fma_f32 v125, v125, v106, -v104
    v_fma_f32 v126, v126, v106, -v104
    v_fma_f32 v127, v127, v106, -v104
    s_waitcnt lgkmcnt(4)
    v_fma_f32 v112, v112, v32, v48
    v_fma_f32 v113, v113, v33, v49
    v_fma_f32 v114, v114, v34, v50
    v_fma_f32 v115, v115, v35, v51
    v_fma_f32 v116, v116, v36, v52
    v_fma_f32 v117, v117, v37, v53
    v_fma_f32 v118, v118, v38, v54
    v_fma_f32 v119, v119, v39, v55
    v_cvt_pk_bf16_f32 v64, v112, v113
    v_cvt_pk_bf16_f32 v65, v114, v115
    v_cvt_pk_bf16_f32 v66, v116, v117
    v_cvt_pk_bf16_f32 v67, v118, v119
    s_waitcnt lgkmcnt(0)
    v_fma_f32 v120, v120, v40, v56
    v_fma_f32 v121, v121, v41, v57
    v_fma_f32 v122, v122, v42, v58
    v_fma_f32 v123, v123, v43, v59
    v_fma_f32 v124, v124, v44, v60
    v_fma_f32 v125, v125, v45, v61
    v_fma_f32 v126, v126, v46, v62
    v_fma_f32 v127, v127, v47, v63
    v_cvt_pk_bf16_f32 v68, v120, v121
    v_cvt_pk_bf16_f32 v69, v122, v123
    v_cvt_pk_bf16_f32 v70, v124, v125
    v_cvt_pk_bf16_f32 v71, v126, v127
    s_cmp_lg_u32 s60, 0
    s_cbranch_scc0 L_slow_3
    buffer_store_dwordx4 v[64:67], v1, s[44:47], s68 offen
    buffer_store_dwordx4 v[68:71], v1, s[44:47], s68 offen offset:1024
    s_waitcnt vmcnt(0)
    s_mov_b64 exec, 1
    buffer_store_dword v14, v13, s[48:51], s70 offen
    s_mov_b64 exec, -1
    s_branch L_stored_4
L_slow_3:
    buffer_store_dwordx4 v[64:67], v1, s[44:47], s68 offen sc1
    buffer_store_dwordx4 v[68:71], v1, s[44:47], s68 offen offset:1024 sc1
    s_waitcnt vmcnt(0)
    s_mov_b64 exec, 1
    buffer_store_dword v14, v13, s[48:51], s70 offen sc1
    s_mov_b64 exec, -1
L_stored_4:
L_poll_5:
    buffer_load_dword v110, v89, s[48:51], s72 offen sc1
    buffer_load_dword v111, v84, s[48:51], s72 offen offset:2048 sc1
    s_waitcnt vmcnt(0)
    v_xor_b32 v109, s59, v110
    v_bitop3_b32 v109, v109, v111, s59 bitop3:0xf6
    v_cmp_ne_u32 vcc, 0, v109
    s_cbranch_vccz L_polled_6
    s_cmp_eq_u32 s61, 0
    s_cbranch_scc1 L_polled_6
    s_sub_u32 s61, s61, 1
    s_sleep 3
    s_branch L_poll_5
L_polled_6:
    s_add_u32 s23, s22, 0
    s_and_b32 s23, s23, 7
    s_lshl_b32 s23, s23, 12
    s_add_u32 s23, s23, s80
    s_add_u32 s3, s23, 524288
    s_add_u32 m0, s81, 0
    s_nop 0
    buffer_load_dwordx4 v1, s[48:51], s3 offen sc1 lds
    s_mov_b32 s25, 4096
    s_lshl_b32 s21, s63, 2
    s_add_u32 s21, s21, s58
    s_lshl_b32 s71, s21, 7
    s_add_u32 s71, s71, 524288
    s_sub_u32 s73, s21, 64
    s_sub_u32 s74, s21, 128
    s_cmp_ge_u32 s56, 1
    s_cselect_b32 s73, s73, s21
    s_cmp_ge_u32 s56, 2
    s_cselect_b32 s74, s74, s21
    s_lshl_b32 s73, s73, 7
    s_lshl_b32 s74, s74, 7
    s_lshl_b32 s24, s21, 12
    s_add_u32 s24, s24, 7340032
    s_sub_u32 s18, s24, 262144
    s_add_u32 s3, s23, 1048576
    s_add_u32 m0, s81, 32768
    s_nop 0
    buffer_load_dwordx4 v1, s[48:51], s3 offen sc1 lds
    s_sub_u32 s19, s24, 524288
    s_cmp_ge_u32 s56, 1
    s_cselect_b32 s18, s18, 0x7f000000
    s_cmp_ge_u32 s56, 2
    s_cselect_b32 s19, s19, 0x7f000000
    v_mov_b32 v7, s73
    v_writelane_b32 v7, s74, 1
    v_accvgpr_write_b32 a253, v7
    s_sub_u32 s97, 3, s58
    s_lshl_b32 s97, s97, 10
    s_add_u32 s97, s97, 148224
    v_add_u32 v7, s97, v1
    s_add_u32 s97, s81, 148224
    v_add_u32 v4, s97, v1
    s_lshl_b32 s21, s56, 2
    s_add_u32 s21, s21, s76
    s_add_u32 s3, s23, 0
    s_add_u32 m0, s81, 65536
    s_nop 0
    buffer_load_dwordx4 v1, s[48:51], s3 offen sc1 lds
    s_lshl_b32 s95, s21, 15
    s_lshl_b32 s97, s77, 6
    s_add_u32 s4, s95, s97
    s_lshl_b32 s97, s77, 1
    s_add_u32 s95, s95, s97
    s_lshl_b32 s5, s21, 6
    s_lshr_b32 s97, s77, 3
    s_add_u32 s5, s5, s97
    s_add_u32 s5, s5, 24576
    s_lshl_b32 s6, s21, 12
    s_add_u32 s6, s6, 262144
    s_bfe_u32 s97, s57, 0x20001
    s_lshl_b32 s97, s97, 10
    s_add_u32 s20, s6, s97
    s_add_u32 s23, s22, 1
    s_and_b32 s23, s23, 7
    s_lshl_b32 s23, s23, 12
    s_add_u32 s23, s23, s80
    s_add_u32 s3, s23, 524288
    s_add_u32 m0, s81, 4096
    s_nop 0
    buffer_load_dwordx4 v1, s[48:51], s3 offen sc1 lds
    s_and_b32 s97, s57, 1
    s_lshl_b32 s97, s97, 3
    s_add_u32 s20, s20, s97
    s_bitcmp0_b32 s58, 0
    s_cselect_b32 s20, s20, 0x7f000000
    s_xor_b32 s36, s21, 1
    s_mov_b32 s37, s21
    s_mul_i32 s40, s36, 88064
    s_mul_i32 s41, s21, 88064
    s_mul_i32 s97, s58, 22528
    s_add_u32 s97, s97, 11534336
    s_add_u32 s40, s40, s97
    s_add_u32 s41, s41, s97
    s_and_b32 s21, s21, -2
    s_lshl_b32 s42, s21, 6
    s_add_u32 s3, s23, 1048576
    s_add_u32 m0, s81, 36864
    s_nop 0
    buffer_load_dwordx4 v1, s[48:51], s3 offen sc1 lds
    s_add_u32 s42, s42, 28672
    s_lshl_b32 s38, s21, 7
    s_lshl_b32 s97, s58, 5
    s_add_u32 s38, s38, s97
    s_add_u32 s38, s38, 16384
    s_lshl_b32 s43, s27, 6
    s_add_u32 s39, s43, 24576
    s_lshl_b32 s97, s57, 2
    s_add_u32 s43, s43, s97
    s_add_u32 s43, s43, 28672
    s_lshl_b32 s74, s56, 2
    s_add_u32 s74, s74, 3
    s_sub_u32 s74, s74, s58
    s_mov_b32 s17, s74
    s_add_u32 s3, s23, 0
    s_add_u32 m0, s81, 69632
    s_nop 0
    buffer_load_dwordx4 v1, s[48:51], s3 offen sc1 lds
    ds_read_b64_tr_b16 v[76:77], v90 offset:0
    ds_read_b64_tr_b16 v[78:79], v90 offset:1024
    ds_read_b64_tr_b16 v[80:81], v90 offset:64
    ds_read_b64_tr_b16 v[82:83], v90 offset:1088
    s_waitcnt lgkmcnt(2)
    buffer_store_dwordx4 v[76:79], v1, s[48:51], s90 offen sc1
    s_waitcnt lgkmcnt(0)
    buffer_store_dwordx4 v[80:83], v1, s[48:51], s91 offen sc1
    s_lshl_b32 s97, s57, 3
    s_lshl_b32 s73, s27, 7
    s_add_u32 s73, s73, s97
    s_lshl_b32 s74, s74, 7
    s_add_u32 s74, s74, s97
    s_add_u32 s74, s74, 4
    v_mov_b32 v8, s73
    v_writelane_b32 v8, s74, 1
    v_add_u32 v8, 16384, v8
    v_accvgpr_write_b32 a243, v8
    s_cmp_ge_u32 s57, 11
    s_cselect_b32 s97, 32, 48
    v_cmp_gt_u32 vcc, s97, v12
    v_lshlrev_b32 v8, 7, v12
    v_mov_b32 v9, 0x7f000000
    s_add_u32 s23, s22, 2
    s_and_b32 s23, s23, 7
    s_lshl_b32 s23, s23, 12
    s_add_u32 s23, s23, s80
    s_add_u32 s3, s23, 524288
    s_add_u32 m0, s81, 8192
    s_nop 0
    buffer_load_dwordx4 v1, s[48:51], s3 offen sc1 lds
    v_cndmask_b32 v8, v9, v8, vcc
    v_accvgpr_write_b32 a249, v8
    v_and_b32 v8, 0x70, v1
    v_bfe_u32 v9, v12, 3, 2
    v_lshl_add_u32 v8, v9, 11, v8
    v_lshrrev_b32 v9, 5, v12
    v_lshl_add_u32 v8, v9, 15, v8
    s_lshl_b32 s97, s77, 2
    v_add_u32 v8, s97, v8
    v_accvgpr_write_b32 a252, v8
    s_lshl_b32 s73, s63, 2
    s_add_u32 s73, s73, 6144
    v_mov_b32 v8, s73
    s_cmp_eq_u32 s63, 0
    s_cselect_b32 s97, 0, 0x7f000000
    s_add_u32 s3, s23, 1048576
    s_add_u32 m0, s81, 40960
    s_nop 0
    buffer_load_dwordx4 v1, s[48:51], s3 offen sc1 lds
    v_writelane_b32 v8, s97, 1
    v_accvgpr_write_b32 a254, v8
    s_lshl_b32 s89, s58, 13
    s_add_u32 s89, s89, 17825792
    s_lshl_b32 s83, s77, 10
    s_xor_b32 s90, s83, 0x8000
    s_add_u32 s83, s83, s89
    s_add_u32 s90, s90, s89
    s_mul_i32 s89, s58, 22528
    s_add_u32 s89, s89, 19922944
    s_lshr_b32 s84, s77, 5
    s_xor_b32 s91, s84, 1
    s_mul_i32 s84, s84, 88064
    s_mul_i32 s91, s91, 88064
    s_add_u32 s3, s23, 0
    s_add_u32 m0, s81, 73728
    s_nop 0
    buffer_load_dwordx4 v1, s[48:51], s3 offen sc1 lds
    s_add_u32 s84, s84, s89
    s_add_u32 s91, s91, s89
    s_mul_i32 s79, s57, 3
    s_lshl_b32 s85, s57, 1
    s_add_u32 s85, s85, 11
    s_min_u32 s79, s79, s85
    s_mul_i32 s85, s58, 44032
    s_lshl_b32 s86, s79, 6
    s_add_u32 s85, s85, s86
    s_mul_i32 s86, s58, 3072
    s_mul_i32 s88, s27, 88064
    s_lshl_b32 s89, s79, 11
    s_add_u32 s88, s88, s89
    s_add_u32 s88, s88, 11534336
    v_and_b32 v13, 15, v12
    v_lshlrev_b32 v13, 2, v13
    s_lshl_b32 s72, s27, 15
L_poll_7:
    buffer_load_dword v15, v13, s[48:51], s69 offen sc1
    s_waitcnt vmcnt(0)
    v_cmp_ne_u32 vcc, s59, v15
    s_cbranch_vccz L_polled_8
    s_cmp_eq_u32 s61, 0
    s_cbranch_scc1 L_polled_8
    s_sub_u32 s61, s61, 1
    s_branch L_poll_7
L_polled_8:
    s_add_u32 s7, s22, 0
    s_and_b32 s7, s7, 7
    s_lshl_b32 s7, s7, 12
    s_add_u32 s7, s7, s72
    buffer_load_dwordx4 v[128:131], v1, s[44:47], s7 offen sc1
    buffer_load_dwordx4 v[132:135], v1, s[44:47], s7 offen offset:1024 sc1
    s_barrier
    ds_read_b128 v[32:35], v1 offset:0
    ds_read_b128 v[36:39], v1 offset:32768
    ds_read_b128 v[40:43], v1 offset:1024
    ds_read_b128 v[44:47], v1 offset:33792
    ds_read_b128 v[48:51], v1 offset:2048
    ds_read_b128 v[52:55], v1 offset:34816
    buffer_load_dwordx4 v[136:139], v1, s[44:47], s7 offen offset:2048 sc1
    buffer_load_dwordx4 v[140:143], v1, s[44:47], s7 offen offset:3072 sc1
    s_add_u32 s7, s22, 1
    s_and_b32 s7, s7, 7
    s_lshl_b32 s7, s7, 12
    s_add_u32 s7, s7, s72
    buffer_load_dwordx4 v[144:147], v1, s[44:47], s7 offen sc1
    buffer_load_dwordx4 v[148:151], v1, s[44:47], s7 offen offset:1024 sc1
    s_waitcnt vmcnt(5) lgkmcnt(4)
    v_mfma_f32_32x32x16_bf16 v[96:111], v[32:35], v[128:131], 0
    buffer_load_dwordx4 v[152:155], v1, s[44:47], s7 offen offset:2048 sc1
    s_mul_i32 s52, s58, 4160
    s_add_u32 s97, s52, 131584
    v_add_u32 v13, s97, v1
    ds_read_b128 v[56:59], v1 offset:3072
    v_mfma_f32_32x32x16_bf16 v[112:127], v[128:131], v[36:39], 0
    s_add_u32 s23, s22, 3
    s_and_b32 s23, s23, 7
    s_lshl_b32 s23, s23, 12
    s_add_u32 s23, s23, s80
    s_add_u32 s3, s23, 524288
    s_add_u32 m0, s81, 12288
    s_nop 0
    buffer_load_dwordx4 v1, s[48:51], s3 offen sc1 lds
    s_mul_i32 s36, s36, s96
    ds_read_b128 v[60:63], v1 offset:35840
    s_waitcnt vmcnt(6) lgkmcnt(4)
    v_mfma_f32_32x32x16_bf16 v[96:111], v[40:43], v[132:135], v[96:111]
    buffer_load_dwordx4 v[156:159], v1, s[44:47], s7 offen offset:3072 sc1
    s_mul_i32 s37, s37, s96
    s_lshl_b32 s97, s58, 13
    s_add_u32 s97, s97, s78
    ds_read_b128 v[32:35], v3 offset:0
    v_mfma_f32_32x32x16_bf16 v[112:127], v[132:135], v[44:47], v[112:127]
    s_add_u32 s3, s23, 1048576
    s_add_u32 m0, s81, 45056
    s_nop 0
    buffer_load_dwordx4 v1, s[48:51], s3 offen sc1 lds
    s_add_u32 s36, s36, s97
    ds_read_b128 v[36:39], v1 offset:4096
    s_waitcnt vmcnt(7) lgkmcnt(4)
    v_mfma_f32_32x32x16_bf16 v[96:111], v[48:51], v[136:139], v[96:111]
    s_add_u32 s7, s22, 2
    s_and_b32 s7, s7, 7
    s_lshl_b32 s7, s7, 12
    s_add_u32 s7, s7, s72
    buffer_load_dwordx4 v[160:163], v1, s[44:47], s7 offen sc1
    s_add_u32 s37, s37, s97
    s_lshl_b32 s97, s57, 11
    s_add_u32 s97, s97, s78
    ds_read_b128 v[40:43], v1 offset:36864
    v_mfma_f32_32x32x16_bf16 v[112:127], v[136:139], v[52:55], v[112:127]
    s_add_u32 s3, s23, 0
    s_add_u32 m0, s81, 77824
    s_nop 0
    buffer_load_dwordx4 v1, s[48:51], s3 offen sc1 lds
    s_mul_i32 s16, s27, s96
    ds_read_b128 v[44:47], v1 offset:5120
    s_waitcnt vmcnt(8) lgkmcnt(4)
    v_mfma_f32_32x32x16_bf16 v[96:111], v[56:59], v[140:143], v[96:111]
    buffer_load_dwordx4 v[164:167], v1, s[44:47], s7 offen offset:1024 sc1
    s_add_u32 s16, s16, s97
    s_mul_i32 s17, s17, s96
    s_add_u32 s17, s17, s97
    ds_read_b128 v[48:51], v1 offset:37888
    v_mfma_f32_32x32x16_bf16 v[112:127], v[140:143], v[60:63], v[112:127]
    s_add_u32 s23, s22, 4
    s_and_b32 s23, s23, 7
    s_lshl_b32 s23, s23, 12
    s_add_u32 s23, s23, s80
    s_add_u32 s3, s23, 524288
    s_add_u32 m0, s81, 16384
    s_nop 0
    buffer_load_dwordx4 v1, s[48:51], s3 offen sc1 lds
    s_lshl_b32 s73, s56, 8
    ds_read_b128 v[52:55], v1 offset:6144
    s_waitcnt lgkmcnt(4)
    v_mfma_f32_32x32x16_bf16 v[80:95], v[32:35], v[128:131], 0
    buffer_load_dwordx4 v[168:171], v1, s[44:47], s7 offen offset:2048 sc1
    s_add_u32 s74, s73, 24832
    v_mov_b32 v8, s74
    v_and_b32 v9, 31, v12
    ds_read_b128 v[56:59], v1 offset:38912
    s_waitcnt vmcnt(10)
    v_mfma_f32_32x32x16_bf16 v[96:111], v[36:39], v[144:147], v[96:111]
    buffer_load_dwordx4 v[172:175], v1, s[44:47], s7 offen offset:3072 sc1
    v_cmp_gt_u32 vcc, 30, v9
    s_add_u32 s97, s73, 20992
    v_mov_b32 v10, s97
    ds_read_b128 v[60:63], v1 offset:7168
    s_waitcnt lgkmcnt(4)
    v_mfma_f32_32x32x16_bf16 v[112:127], v[144:147], v[40:43], v[112:127]
    s_add_u32 s3, s23, 1048576
    s_add_u32 m0, s81, 49152
    s_nop 0
    buffer_load_dwordx4 v1, s[48:51], s3 offen sc1 lds
    ds_read_b128 v[32:35], v1 offset:39936
    s_waitcnt vmcnt(11)
    v_mfma_f32_32x32x16_bf16 v[96:111], v[44:47], v[148:151], v[96:111]
    s_add_u32 s7, s22, 3
    s_and_b32 s7, s7, 7
    s_lshl_b32 s7, s7, 12
    s_add_u32 s7, s7, s72
    buffer_load_dwordx4 v[176:179], v1, s[44:47], s7 offen sc1
    v_cndmask_b32 v8, v8, v10, vcc
    v_cmp_gt_u32 vcc, 28, v9
    s_lshl_b32 s97, s56, 9
    ds_read_b128 v[36:39], v3 offset:1024
    s_waitcnt lgkmcnt(4)
    v_mfma_f32_32x32x16_bf16 v[112:127], v[148:151], v[48:51], v[112:127]
    s_add_u32 s3, s23, 0
    s_add_u32 m0, s81, 81920
    s_nop 0
    buffer_load_dwordx4 v1, s[48:51], s3 offen sc1 lds
    s_add_u32 s97, s97, 13312
    ds_read_b128 v[40:43], v1 offset:8192
    s_waitcnt vmcnt(12)
    v_mfma_f32_32x32x16_bf16 v[96:111], v[52:55], v[152:155], v[96:111]
    buffer_load_dwordx4 v[180:183], v1, s[44:47], s7 offen offset:1024 sc1
    v_mov_b32 v10, s97
    v_cndmask_b32 v8, v8, v10, vcc
    ds_read_b128 v[44:47], v1 offset:40960
    s_waitcnt lgkmcnt(4)
    v_mfma_f32_32x32x16_bf16 v[112:127], v[152:155], v[56:59], v[112:127]
    s_add_u32 s23, s22, 5
    s_and_b32 s23, s23, 7
    s_lshl_b32 s23, s23, 12
    s_add_u32 s23, s23, s80
    s_add_u32 s3, s23, 524288
    s_add_u32 m0, s81, 20480
    s_nop 0
    buffer_load_dwordx4 v1, s[48:51], s3 offen sc1 lds
    v_cmp_gt_u32 vcc, 24, v9
    ds_read_b128 v[48:51], v1 offset:9216
    s_waitcnt vmcnt(12)
    v_mfma_f32_32x32x16_bf16 v[96:111], v[60:63], v[156:159], v[96:111]
    buffer_load_dwordx4 v[184:187], v1, s[44:47], s7 offen offset:2048 sc1
    s_bfe_u32 s97, s57, 0x20001
    s_lshl_b32 s97, s97, 10
    s_add_u32 s97, s97, s6
    ds_read_b128 v[52:55], v1 offset:41984
    s_waitcnt lgkmcnt(4)
    v_mfma_f32_32x32x16_bf16 v[112:127], v[156:159], v[32:35], v[112:127]
    s_add_u32 s3, s23, 1048576
    s_add_u32 m0, s81, 53248
    s_nop 0
    buffer_load_dwordx4 v1, s[48:51], s3 offen sc1 lds
    s_sub_u32 s97, s97, 2048
    ds_read_b128 v[56:59], v1 offset:10240
    v_mfma_f32_32x32x16_bf16 v[80:95], v[36:39], v[132:135], v[80:95]
    v_mov_b32 v10, s97
    v_cndmask_b32 v8, v8, v10, vcc
    v_cmp_gt_u32 vcc, 16, v9
    ds_read_b128 v[60:63], v1 offset:43008
    s_waitcnt vmcnt(12) lgkmcnt(4)
    v_mfma_f32_32x32x16_bf16 v[96:111], v[40:43], v[160:163], v[96:111]
    buffer_load_dwordx4 v[188:191], v1, s[44:47], s7 offen offset:3072 sc1
    s_mov_b32 s97, s17
    v_mov_b32 v10, s97
    ds_read_b128 v[32:35], v1 offset:11264
    v_mfma_f32_32x32x16_bf16 v[112:127], v[160:163], v[44:47], v[112:127]
    s_add_u32 s3, s23, 0
    s_add_u32 m0, s81, 86016
    s_nop 0
    buffer_load_dwordx4 v1, s[48:51], s3 offen sc1 lds
    v_cndmask_b32 v8, v8, v10, vcc
    ds_read_b128 v[36:39], v1 offset:44032
    s_waitcnt vmcnt(12) lgkmcnt(4)
    v_mfma_f32_32x32x16_bf16 v[96:111], v[48:51], v[164:167], v[96:111]
    s_add_u32 s7, s22, 4
    s_and_b32 s7, s7, 7
    s_lshl_b32 s7, s7, 12
    s_add_u32 s7, s7, s72
    buffer_load_dwordx4 v[192:195], v1, s[44:47], s7 offen sc1
    v_cmp_gt_u32 vcc, 8, v9
    s_mov_b32 s97, s16
    v_mov_b32 v10, s97
    ds_read_b128 v[40:43], v3 offset:2048
    v_mfma_f32_32x32x16_bf16 v[112:127], v[164:167], v[52:55], v[112:127]
    s_barrier
    s_add_u32 s23, s22, 6
    s_and_b32 s23, s23, 7
    s_lshl_b32 s23, s23, 12
    s_add_u32 s23, s23, s80
    s_add_u32 s3, s23, 524288
    s_add_u32 m0, s81, 24576
    s_nop 0
    buffer_load_dwordx4 v1, s[48:51], s3 offen sc1 lds
    ds_read_b128 v[44:47], v1 offset:12288
    s_waitcnt vmcnt(12) lgkmcnt(4)
    v_mfma_f32_32x32x16_bf16 v[96:111], v[56:59], v[168:171], v[96:111]
    buffer_load_dwordx4 v[196:199], v1, s[44:47], s7 offen offset:1024 sc1
    v_cndmask_b32 v8, v8, v10, vcc
    v_lshl_add_u32 v8, v9, 7, v8
    s_add_u32 s17, s17, 1024
    ds_read_b128 v[48:51], v1 offset:45056
    v_mfma_f32_32x32x16_bf16 v[112:127], v[168:171], v[60:63], v[112:127]
    s_add_u32 s3, s23, 1048576
    s_add_u32 m0, s81, 57344
    s_nop 0
    buffer_load_dwordx4 v1, s[48:51], s3 offen sc1 lds
    v_accvgpr_write_b32 a248, v8
    ds_read_b128 v[52:55], v1 offset:13312
    s_waitcnt vmcnt(13) lgkmcnt(4)
    v_mfma_f32_32x32x16_bf16 v[96:111], v[32:35], v[172:175], v[96:111]
    buffer_load_dwordx4 v[200:203], v1, s[44:47], s7 offen offset:2048 sc1
    s_lshr_b32 s82, s63, 3
    s_lshl_b32 s82, s82, 8
    s_lshl_b32 s97, s58, 6
    ds_read_b128 v[56:59], v1 offset:46080
    v_mfma_f32_32x32x16_bf16 v[112:127], v[172:175], v[36:39], v[112:127]
    s_add_u32 s3, s23, 0
    s_add_u32 m0, s81, 90112
    s_nop 0
    buffer_load_dwordx4 v1, s[48:51], s3 offen sc1 lds
    s_add_u32 s82, s82, s97
    ds_read_b128 v[60:63], v1 offset:14336
    s_waitcnt lgkmcnt(4)
    v_mfma_f32_32x32x16_bf16 v[80:95], v[40:43], v[136:139], v[80:95]
    buffer_load_dwordx4 v[204:207], v1, s[44:47], s7 offen offset:3072 sc1
    s_and_b32 s97, s63, 7
    s_lshl_b32 s97, s97, 13
    s_add_u32 s82, s82, s97
    ds_read_b128 v[32:35], v1 offset:47104
    s_waitcnt vmcnt(14)
    v_mfma_f32_32x32x16_bf16 v[96:111], v[44:47], v[176:179], v[96:111]
    s_add_u32 s7, s22, 5
    s_and_b32 s7, s7, 7
    s_lshl_b32 s7, s7, 12
    s_add_u32 s7, s7, s72
    buffer_load_dwordx4 v[208:211], v1, s[44:47], s7 offen sc1
    s_add_u32 s82, s82, 65536
    v_lshrrev_b32 v9, 1, v12
    v_lshlrev_b32 v9, 7, v9
    ds_read_b128 v[36:39], v1 offset:15360
    s_waitcnt lgkmcnt(4)
    v_mfma_f32_32x32x16_bf16 v[112:127], v[176:179], v[48:51], v[112:127]
    s_add_u32 s23, s22, 7
    s_and_b32 s23, s23, 7
    s_lshl_b32 s23, s23, 12
    s_add_u32 s23, s23, s80
    s_add_u32 s3, s23, 524288
    s_add_u32 m0, s81, 28672
    s_nop 0
    buffer_load_dwordx4 v1, s[48:51], s3 offen sc1 lds
    v_and_b32 v10, 16, v1
    ds_read_b128 v[40:43], v1 offset:48128
    s_waitcnt vmcnt(14)
    v_mfma_f32_32x32x16_bf16 v[96:111], v[52:55], v[180:183], v[96:111]
    buffer_load_dwordx4 v[212:215], v1, s[44:47], s7 offen offset:1024 sc1
    s_lshl_b32 s97, s58, 5
    s_add_u32 s97, s97, 154624
    v_add3_u32 v9, v9, v10, s97
    ds_read_b128 v[44:47], v3 offset:3072
    s_waitcnt lgkmcnt(4)
    v_mfma_f32_32x32x16_bf16 v[112:127], v[180:183], v[56:59], v[112:127]
    s_barrier
    s_add_u32 s3, s23, 1048576
    s_add_u32 m0, s81, 61440
    s_nop 0
    buffer_load_dwordx4 v1, s[48:51], s3 offen sc1 lds
    ds_read_b128 v[72:75], v9 offset:0
    ds_read_b128 v[48:51], v1 offset:16384
    s_waitcnt vmcnt(14)
    v_mfma_f32_32x32x16_bf16 v[96:111], v[60:63], v[184:187], v[96:111]
    buffer_load_dwordx4 v[216:219], v1, s[44:47], s7 offen offset:2048 sc1
    v_accvgpr_read_b32 v10, a250
    v_lshlrev_b32 v10, 16, v10
    v_mul_f32 v77, 0xbfb8aa3b, v10
    ds_read_b128 v[52:55], v1 offset:49152
    s_waitcnt lgkmcnt(5)
    v_mfma_f32_32x32x16_bf16 v[112:127], v[184:187], v[32:35], v[112:127]
    s_add_u32 s3, s23, 0
    s_add_u32 m0, s81, 94208
    s_nop 0
    buffer_load_dwordx4 v1, s[48:51], s3 offen sc1 lds
    v_exp_f32 v77, v77
    ds_read_b128 v[56:59], v1 offset:17408
    s_waitcnt vmcnt(14)
    v_mfma_f32_32x32x16_bf16 v[96:111], v[36:39], v[188:191], v[96:111]
    buffer_load_dwordx4 v[220:223], v1, s[44:47], s7 offen offset:3072 sc1
    v_add_f32 v77, 1.0, v77
    v_rcp_f32 v77, v77
    ds_read_b128 v[60:63], v1 offset:50176
    s_waitcnt lgkmcnt(5)
    v_mfma_f32_32x32x16_bf16 v[112:127], v[188:191], v[40:43], v[112:127]
    s_add_u32 s7, s22, 6
    s_and_b32 s7, s7, 7
    s_lshl_b32 s7, s7, 12
    s_add_u32 s7, s7, s72
    buffer_load_dwordx4 v[224:227], v1, s[44:47], s7 offen sc1
    v_mul_f32 v10, v10, v77
    v_cvt_pk_bf16_f32 v10, v10, v10
    ds_read_b128 v[32:35], v1 offset:18432
    v_mfma_f32_32x32x16_bf16 v[80:95], v[44:47], v[140:143], v[80:95]
    v_and_b32 v10, s26, v10
    s_waitcnt lgkmcnt(5)
    v_lshlrev_b32 v76, 16, v72
    v_and_b32 v77, s26, v72
    ds_read_b128 v[36:39], v1 offset:51200
    s_waitcnt vmcnt(14) lgkmcnt(4)
    v_mfma_f32_32x32x16_bf16 v[96:111], v[48:51], v[192:195], v[96:111]
    buffer_load_dwordx4 v[228:231], v1, s[44:47], s7 offen offset:1024 sc1
    v_mul_f32 v64, v10, v76
    v_mul_f32 v65, v10, v77
    v_lshlrev_b32 v76, 16, v73
    ds_read_b128 v[40:43], v1 offset:19456
    v_mfma_f32_32x32x16_bf16 v[112:127], v[192:195], v[52:55], v[112:127]
    v_and_b32 v77, s26, v73
    v_mul_f32 v66, v10, v76
    v_mul_f32 v67, v10, v77
    v_lshlrev_b32 v76, 16, v74
    ds_read_b128 v[44:47], v1 offset:52224
    s_waitcnt vmcnt(13) lgkmcnt(4)
    v_mfma_f32_32x32x16_bf16 v[96:111], v[56:59], v[196:199], v[96:111]
    buffer_load_dwordx4 v[232:235], v1, s[44:47], s7 offen offset:2048 sc1
    v_and_b32 v77, s26, v74
    v_mul_f32 v68, v10, v76
    v_mul_f32 v69, v10, v77
    ds_read_b128 v[48:51], v3 offset:4096
    v_mfma_f32_32x32x16_bf16 v[112:127], v[196:199], v[60:63], v[112:127]
    s_barrier
    v_lshlrev_b32 v76, 16, v75
    v_and_b32 v77, s26, v75
    v_mul_f32 v70, v10, v76
    v_mul_f32 v71, v10, v77
    ds_read_b128 v[52:55], v1 offset:20480
    s_waitcnt vmcnt(12) lgkmcnt(4)
    v_mfma_f32_32x32x16_bf16 v[96:111], v[32:35], v[200:203], v[96:111]
    buffer_load_dwordx4 v[236:239], v1, s[44:47], s7 offen offset:3072 sc1
    ds_read_b128 v[72:75], v9 offset:4096
    v_accvgpr_read_b32 v10, a251
    v_lshlrev_b32 v10, 16, v10
    ds_read_b128 v[56:59], v1 offset:53248
    v_mfma_f32_32x32x16_bf16 v[112:127], v[200:203], v[36:39], v[112:127]
    v_mul_f32 v77, 0xbfb8aa3b, v10
    v_exp_f32 v77, v77
    s_nop 0
    v_add_f32 v77, 1.0, v77
    ds_read_b128 v[60:63], v1 offset:21504
    s_waitcnt vmcnt(11) lgkmcnt(5)
    v_mfma_f32_32x32x16_bf16 v[96:111], v[40:43], v[204:207], v[96:111]
    s_add_u32 s7, s22, 7
    s_and_b32 s7, s7, 7
    s_lshl_b32 s7, s7, 12
    s_add_u32 s7, s7, s72
    buffer_load_dwordx4 v[240:243], v1, s[44:47], s7 offen sc1
    v_rcp_f32 v77, v77
    s_nop 0
    v_mul_f32 v10, v10, v77
    ds_read_b128 v[32:35], v1 offset:54272
    v_mfma_f32_32x32x16_bf16 v[112:127], v[204:207], v[44:47], v[112:127]
    v_cvt_pk_bf16_f32 v10, v10, v10
    v_and_b32 v10, s26, v10
    s_waitcnt lgkmcnt(3)
    v_lshlrev_b32 v76, 16, v72
    ds_read_b128 v[36:39], v1 offset:22528
    v_mfma_f32_32x32x16_bf16 v[80:95], v[48:51], v[144:147], v[80:95]
    buffer_load_dwordx4 v[244:247], v1, s[44:47], s7 offen offset:1024 sc1
    v_and_b32 v77, s26, v72
    v_fmac_f32 v64, v10, v76
    v_fmac_f32 v65, v10, v77
    ds_read_b128 v[40:43], v1 offset:55296
    s_waitcnt vmcnt(12)
    v_mfma_f32_32x32x16_bf16 v[96:111], v[52:55], v[208:211], v[96:111]
    buffer_load_dwordx4 v[248:251], v1, s[44:47], s7 offen offset:2048 sc1
    v_lshlrev_b32 v76, 16, v73
    v_and_b32 v77, s26, v73
    v_fmac_f32 v66, v10, v76
    ds_read_b128 v[44:47], v1 offset:23552
    s_waitcnt lgkmcnt(4)
    v_mfma_f32_32x32x16_bf16 v[112:127], v[208:211], v[56:59], v[112:127]
    buffer_load_dwordx4 v[252:255], v1, s[44:47], s7 offen offset:3072 sc1
    v_fmac_f32 v67, v10, v77
    v_lshlrev_b32 v76, 16, v74
    v_and_b32 v77, s26, v74
    ds_read_b128 v[48:51], v1 offset:56320
    s_waitcnt vmcnt(12)
    v_mfma_f32_32x32x16_bf16 v[96:111], v[60:63], v[212:215], v[96:111]
    v_mov_b32 v15, 0
    s_mov_b64 exec, 1
    buffer_store_dword v14, v15, s[48:51], s67 offen sc1
    s_mov_b64 exec, -1
    v_fmac_f32 v68, v10, v76
    ds_read_b128 v[52:55], v3 offset:5120
    s_waitcnt lgkmcnt(4)
    v_mfma_f32_32x32x16_bf16 v[112:127], v[212:215], v[32:35], v[112:127]
    s_barrier
    v_accvgpr_read_b32 v5, a248
    s_mov_b32 m0, 162816
    s_mov_b32 exec_hi, 0
    buffer_load_dword v5, s[48:51], 0 offen lds
    s_mov_b32 exec_hi, -1
    v_fmac_f32 v69, v10, v77
    ds_read_b128 v[56:59], v1 offset:24576
    s_waitcnt vmcnt(12)
    v_mfma_f32_32x32x16_bf16 v[96:111], v[36:39], v[216:219], v[96:111]
    v_lshlrev_b32 v76, 16, v75
    v_and_b32 v77, s26, v75
    v_fmac_f32 v70, v10, v76
    v_fmac_f32 v71, v10, v77
    ds_read_b128 v[60:63], v1 offset:57344
    s_waitcnt lgkmcnt(4)
    v_mfma_f32_32x32x16_bf16 v[112:127], v[216:219], v[40:43], v[112:127]
    v_and_b32 v9, 1, v12
    v_lshlrev_b32 v10, 5, v9
    v_permlane32_swap_b32 v64, v68
    v_permlane32_swap_b32 v65, v69
    ds_read_b128 v[32:35], v1 offset:25600
    s_waitcnt vmcnt(10)
    v_mfma_f32_32x32x16_bf16 v[96:111], v[44:47], v[220:223], v[96:111]
    v_permlane32_swap_b32 v66, v70
    v_permlane32_swap_b32 v67, v71
    v_add_f32 v64, v64, v68
    v_add_f32 v65, v65, v69
    ds_read_b128 v[36:39], v1 offset:58368
    s_waitcnt lgkmcnt(4)
    v_mfma_f32_32x32x16_bf16 v[112:127], v[220:223], v[48:51], v[112:127]
    v_add_f32 v66, v66, v70
    v_add_f32 v67, v67, v71
    v_lshrrev_b32 v9, 5, v12
    v_lshl_add_u32 v10, v9, 4, v10
    ds_read_b128 v[40:43], v1 offset:26624
    v_mfma_f32_32x32x16_bf16 v[80:95], v[52:55], v[148:151], v[80:95]
    v_permlane16_swap_b32 v64, v66
    v_permlane16_swap_b32 v65, v67
    v_add_f32 v64, v64, v66
    v_add_f32 v65, v65, v67
    ds_read_b128 v[44:47], v1 offset:59392
    s_waitcnt vmcnt(9) lgkmcnt(4)
    v_mfma_f32_32x32x16_bf16 v[96:111], v[56:59], v[224:227], v[96:111]
    v_bfe_u32 v9, v12, 4, 1
    v_lshl_add_u32 v10, v9, 3, v10
    v_add_f32_dpp v64, v64, v64 row_ror:8 row_mask:0xf bank_mask:0xf
    v_add_f32_dpp v65, v65, v65 row_ror:8 row_mask:0xf bank_mask:0xf
    ds_read_b128 v[48:51], v1 offset:27648
    v_mfma_f32_32x32x16_bf16 v[112:127], v[224:227], v[60:63], v[112:127]
    v_add_f32_dpp v64, v64, v64 row_ror:4 row_mask:0xf bank_mask:0xf
    v_add_f32_dpp v65, v65, v65 row_ror:4 row_mask:0xf bank_mask:0xf
    ds_read_b128 v[52:55], v1 offset:60416
    s_waitcnt vmcnt(8) lgkmcnt(4)
    v_mfma_f32_32x32x16_bf16 v[96:111], v[32:35], v[228:231], v[96:111]
    v_add_f32_dpp v64, v64, v64 row_ror:2 row_mask:0xf bank_mask:0xf
    v_add_f32_dpp v65, v65, v65 row_ror:2 row_mask:0xf bank_mask:0xf
    ds_read_b128 v[56:59], v3 offset:6144
    v_mfma_f32_32x32x16_bf16 v[112:127], v[228:231], v[36:39], v[112:127]
    s_barrier
    s_mov_b32 exec_lo, 0x00030003
    s_mov_b32 exec_hi, 0x00030003
    buffer_store_dwordx2 v[64:65], v10, s[48:51], s82 offen sc1
    s_mov_b64 exec, -1
    ds_read_b128 v[60:63], v1 offset:28672
    s_waitcnt vmcnt(8) lgkmcnt(4)
    v_mfma_f32_32x32x16_bf16 v[96:111], v[40:43], v[232:235], v[96:111]
    ds_read_b128 v[32:35], v1 offset:61440
    v_mfma_f32_32x32x16_bf16 v[112:127], v[232:235], v[44:47], v[112:127]
    ds_read_b128 v[36:39], v1 offset:29696
    s_waitcnt vmcnt(7) lgkmcnt(4)
    v_mfma_f32_32x32x16_bf16 v[96:111], v[48:51], v[236:239], v[96:111]
    ds_read_b128 v[40:43], v1 offset:62464
    v_mfma_f32_32x32x16_bf16 v[112:127], v[236:239], v[52:55], v[112:127]
    ds_read_b128 v[44:47], v1 offset:30720
    s_waitcnt lgkmcnt(4)
    v_mfma_f32_32x32x16_bf16 v[80:95], v[56:59], v[152:155], v[80:95]
    ds_read_b128 v[48:51], v1 offset:63488
    s_waitcnt vmcnt(6)
    v_mfma_f32_32x32x16_bf16 v[96:111], v[60:63], v[240:243], v[96:111]
    ds_read_b128 v[52:55], v1 offset:31744
    s_waitcnt lgkmcnt(4)
    v_mfma_f32_32x32x16_bf16 v[112:127], v[240:243], v[32:35], v[112:127]
    ds_read_b128 v[56:59], v1 offset:64512
    s_waitcnt vmcnt(5)
    v_mfma_f32_32x32x16_bf16 v[96:111], v[36:39], v[244:247], v[96:111]
    ds_read_b128 v[60:63], v3 offset:7168
    s_waitcnt lgkmcnt(4)
    v_mfma_f32_32x32x16_bf16 v[112:127], v[244:247], v[40:43], v[112:127]
    ds_read_b128 v[32:35], v3 offset:8192
    s_waitcnt vmcnt(4)
    v_mfma_f32_32x32x16_bf16 v[96:111], v[44:47], v[248:251], v[96:111]
    ds_read_b128 v[36:39], v3 offset:9216
    s_waitcnt lgkmcnt(4)
    v_mfma_f32_32x32x16_bf16 v[112:127], v[248:251], v[48:51], v[112:127]
    ds_read_b128 v[40:43], v3 offset:10240
    s_waitcnt vmcnt(3)
    v_mfma_f32_32x32x16_bf16 v[96:111], v[52:55], v[252:255], v[96:111]
    ds_read_b128 v[44:47], v3 offset:11264
    s_waitcnt lgkmcnt(4)
    v_mfma_f32_32x32x16_bf16 v[112:127], v[252:255], v[56:59], v[112:127]
    ds_read_b128 v[48:51], v3 offset:12288
    v_mfma_f32_32x32x16_bf16 v[80:95], v[60:63], v[156:159], v[80:95]
    ds_read_b128 v[52:55], v3 offset:13312
    s_waitcnt lgkmcnt(4)
    v_mfma_f32_32x32x16_bf16 v[80:95], v[32:35], v[160:163], v[80:95]
    ds_read_b128 v[56:59], v3 offset:14336
    v_mfma_f32_32x32x16_bf16 v[80:95], v[36:39], v[164:167], v[80:95]
    s_nop 1
    v_cvt_pk_bf16_f32 v64, v96, v97
    v_cvt_pk_bf16_f32 v65, v98, v99
    v_cvt_pk_bf16_f32 v66, v100, v101
    ds_read_b128 v[60:63], v3 offset:15360
    s_waitcnt lgkmcnt(4)
    v_mfma_f32_32x32x16_bf16 v[80:95], v[40:43], v[168:171], v[80:95]
    v_cvt_pk_bf16_f32 v67, v102, v103
    buffer_store_dwordx4 v[64:67], v1, s[48:51], s24 offen sc1
    ds_write_b128 v13, v[64:67] offset:0
    ds_read_b128 v[32:35], v3 offset:16384
    v_mfma_f32_32x32x16_bf16 v[80:95], v[44:47], v[172:175], v[80:95]
    v_cvt_pk_bf16_f32 v68, v104, v105
    v_cvt_pk_bf16_f32 v69, v106, v107
    v_cvt_pk_bf16_f32 v70, v108, v109
    ds_read_b128 v[36:39], v3 offset:17408
    s_waitcnt lgkmcnt(5)
    v_mfma_f32_32x32x16_bf16 v[80:95], v[48:51], v[176:179], v[80:95]
    v_cvt_pk_bf16_f32 v71, v110, v111
    buffer_store_dwordx4 v[68:71], v1, s[48:51], s24 offen offset:1024 sc1
    ds_write_b128 v13, v[68:71] offset:1024
    ds_read_b128 v[40:43], v3 offset:18432
    v_mfma_f32_32x32x16_bf16 v[80:95], v[52:55], v[180:183], v[80:95]
    v_cvt_pk_bf16_f32 v72, v112, v113
    v_cvt_pk_bf16_f32 v73, v114, v115
    v_cvt_pk_bf16_f32 v74, v116, v117
    ds_read_b128 v[44:47], v3 offset:19456
    s_waitcnt lgkmcnt(6)
    v_mfma_f32_32x32x16_bf16 v[80:95], v[56:59], v[184:187], v[80:95]
    v_cvt_pk_bf16_f32 v75, v118, v119
    buffer_store_dwordx4 v[72:75], v1, s[48:51], s24 offen offset:2048 sc1
    ds_write_b128 v13, v[72:75] offset:2048
    ds_read_b128 v[48:51], v3 offset:20480
    v_mfma_f32_32x32x16_bf16 v[80:95], v[60:63], v[188:191], v[80:95]
    v_cvt_pk_bf16_f32 v76, v120, v121
    v_cvt_pk_bf16_f32 v77, v122, v123
    v_cvt_pk_bf16_f32 v78, v124, v125
    ds_read_b128 v[52:55], v3 offset:21504
    s_waitcnt lgkmcnt(6)
    v_mfma_f32_32x32x16_bf16 v[80:95], v[32:35], v[192:195], v[80:95]
    v_cvt_pk_bf16_f32 v79, v126, v127
    buffer_store_dwordx4 v[76:79], v1, s[48:51], s24 offen offset:3072 sc1
    ds_write_b128 v13, v[76:79] offset:3072
    ds_read_b128 v[56:59], v3 offset:22528
    v_mfma_f32_32x32x16_bf16 v[80:95], v[36:39], v[196:199], v[80:95]
    v_lshlrev_b32 v5, 3, v1
    s_lshl_b32 s3, s63, 2
    s_add_u32 s3, s3, s58
    s_mul_i32 s3, s3, 1408
    s_mov_b32 m0, 162816
    s_mov_b64 exec, 0x7ff
    buffer_load_dword v5, s[12:15], s3 offen lds
    s_mov_b64 exec, -1
    ds_read_b128 v[60:63], v3 offset:23552
    s_waitcnt lgkmcnt(6)
    v_mfma_f32_32x32x16_bf16 v[80:95], v[40:43], v[200:203], v[80:95]
    ds_read_b128 v[32:35], v3 offset:24576
    v_mfma_f32_32x32x16_bf16 v[80:95], v[44:47], v[204:207], v[80:95]
    ds_read_b128 v[36:39], v3 offset:25600
    s_waitcnt lgkmcnt(5)
    v_mfma_f32_32x32x16_bf16 v[80:95], v[48:51], v[208:211], v[80:95]
    ds_read_b128 v[40:43], v3 offset:26624
    v_mfma_f32_32x32x16_bf16 v[80:95], v[52:55], v[212:215], v[80:95]
    ds_read_b128 v[44:47], v3 offset:27648
    s_waitcnt lgkmcnt(4)
    v_mfma_f32_32x32x16_bf16 v[80:95], v[56:59], v[216:219], v[80:95]
    ds_read_b128 v[48:51], v3 offset:28672
    v_mfma_f32_32x32x16_bf16 v[80:95], v[60:63], v[220:223], v[80:95]
    ds_read_b128 v[52:55], v3 offset:29696
    s_waitcnt lgkmcnt(4)
    v_mfma_f32_32x32x16_bf16 v[80:95], v[32:35], v[224:227], v[80:95]
    ds_read_b128 v[56:59], v3 offset:30720
    v_mfma_f32_32x32x16_bf16 v[80:95], v[36:39], v[228:231], v[80:95]
    ds_read_b128 v[60:63], v3 offset:31744
    s_waitcnt lgkmcnt(4)
    v_mfma_f32_32x32x16_bf16 v[80:95], v[40:43], v[232:235], v[80:95]
    v_mfma_f32_32x32x16_bf16 v[80:95], v[44:47], v[236:239], v[80:95]
    s_waitcnt lgkmcnt(2)
    v_mfma_f32_32x32x16_bf16 v[80:95], v[48:51], v[240:243], v[80:95]
    v_mfma_f32_32x32x16_bf16 v[80:95], v[52:55], v[244:247], v[80:95]
    s_waitcnt lgkmcnt(0)
    v_mfma_f32_32x32x16_bf16 v[80:95], v[56:59], v[248:251], v[80:95]
    v_mfma_f32_32x32x16_bf16 v[80:95], v[60:63], v[252:255], v[80:95]
    v_add_u32 v176, 98304, v1
    v_mov_b32 v181, 102400
    v_mul_u32_u24 v182, 4160, v12
    v_add_u32 v182, v182, v181
    s_lshl_b32 s3, s56, 2
    s_sub_i32 s3, 8, s3
    v_cmp_le_i32 vcc, s3, v12
    v_mov_b32 v161, 0x3f803f80
    s_nop 0
    v_cndmask_b32 v160, 0, v161, vcc
    v_mov_b32 v161, v160
    v_mov_b32 v162, v160
    v_mov_b32 v163, v160
    s_mov_b64 exec, 0xfff
    ds_write_b128 v182, v[160:163]
    s_mov_b64 exec, -1
    s_mov_b32 vcc_lo, 0xffff
    s_mov_b32 vcc_hi, 0xffff
    v_add_u32 v182, 2048, v176
    v_cndmask_b32 v177, v181, v182, vcc
    v_cndmask_b32 v179, v182, v181, vcc
    v_add_u32 v182, 3072, v176
    v_cndmask_b32 v178, v181, v182, vcc
    v_cndmask_b32 v180, v182, v181, vcc
    v_sub_f32 v48, v11, v16
    v_sub_f32 v49, v11, v17
    v_sub_f32 v50, v11, v18
    v_sub_f32 v51, v11, v19
    v_sub_f32 v52, v11, v20
    v_sub_f32 v53, v11, v21
    v_sub_f32 v54, v11, v22
    v_sub_f32 v55, v11, v23
    v_sub_f32 v56, v11, v24
    v_sub_f32 v57, v11, v25
    v_sub_f32 v58, v11, v26
    v_sub_f32 v59, v11, v27
    v_sub_f32 v60, v11, v28
    v_sub_f32 v61, v11, v29
    v_sub_f32 v62, v11, v30
    v_sub_f32 v63, v11, v31
    v_mul_f32 v88, 0x3eb8aa3b, v88
    v_mul_f32 v89, 0x3eb8aa3b, v89
    v_mul_f32 v90, 0x3eb8aa3b, v90
    v_mul_f32 v91, 0x3eb8aa3b, v91
    v_mul_f32 v92, 0x3eb8aa3b, v92
    v_mul_f32 v93, 0x3eb8aa3b, v93
    v_mul_f32 v94, 0x3eb8aa3b, v94
    v_mul_f32 v95, 0x3eb8aa3b, v95
    v_cvt_pk_bf16_f32 v36, v88, v89
    v_cvt_pk_bf16_f32 v37, v90, v91
    v_cvt_pk_bf16_f32 v38, v92, v93
    v_cvt_pk_bf16_f32 v39, v94, v95
    ds_write_b128 v7, v[36:39]
    v_mul_f32 v80, 0x3eb8aa3b, v80
    v_mul_f32 v81, 0x3eb8aa3b, v81
    v_mul_f32 v82, 0x3eb8aa3b, v82
    v_mul_f32 v83, 0x3eb8aa3b, v83
    v_mul_f32 v84, 0x3eb8aa3b, v84
    v_mul_f32 v85, 0x3eb8aa3b, v85
    v_mul_f32 v86, 0x3eb8aa3b, v86
    v_mul_f32 v87, 0x3eb8aa3b, v87
    v_cvt_pk_bf16_f32 v32, v80, v81
    v_cvt_pk_bf16_f32 v33, v82, v83
    v_cvt_pk_bf16_f32 v34, v84, v85
    v_cvt_pk_bf16_f32 v35, v86, v87
    v_mov_b32 v14, s59
    v_mov_b32 v15, 0
    s_waitcnt vmcnt(1)
    s_mov_b64 exec, 1
    buffer_store_dword v14, v15, s[48:51], s71 offen sc1
    s_mov_b64 exec, -1
    v_mov_b32 v221, v4
    v_mov_b32 v4, v32
    v_mov_b32 v5, v33
    v_mov_b32 v6, v34
    v_mov_b32 v7, v35
    v_accvgpr_read_b32 v232, a240
    v_accvgpr_read_b32 v233, a241
    v_accvgpr_read_b32 v234, a242
    v_accvgpr_read_b32 v228, a248
    v_accvgpr_read_b32 v230, a252
    v_accvgpr_read_b32 v222, a253
    v_accvgpr_read_b32 v13, a254
    v_accvgpr_read_b32 v255, a255
    v_lshrrev_b32 v229, 2, v12
    v_and_b32 v231, 48, v1
    v_lshl_add_u32 v229, v229, 10, v231
    s_cmp_eq_u32 s58, 0
    s_cselect_b32 s64, 0, 0x7f000000
    s_mov_b32 s69, 524288
    s_mov_b32 s74, 6144
    s_waitcnt lgkmcnt(0)
    s_barrier
    ds_read_b128 v[8:11], v221
    s_mov_b64 exec, 1
    buffer_store_dword v14, v13, s[48:51], s64 offen sc1
    s_mov_b64 exec, -1
    s_lshl_b32 s3, s92, 8
    v_lshl_add_u32 v224, v12, 7, s3
    v_min_u32 v224, (L_code_end-L_att_done-4), v224
    s_getpc_b64 s[54:55]
L_pc_9:
    s_add_u32 s54, s54, (L_att_done-L_pc_9)
    s_addc_u32 s55, s55, 0
    v_mov_b32 v225, s55
    v_add_co_u32 v224, vcc, s54, v224
    s_nop 1
    v_addc_co_u32 v225, vcc, 0, v225, vcc
    s_mov_b32 m0, 162816
    s_mov_b64 exec, 3
    global_load_lds_dword v[224:225], off
    s_mov_b64 exec, -1
    s_cmp_eq_u32 s58, 1
    s_cbranch_scc1 L_att1
    s_cmp_eq_u32 s58, 2
    s_cbranch_scc1 L_att2
    s_cmp_eq_u32 s58, 3
    s_cbranch_scc1 L_att3
    ds_read_b128 v[128:131], v176 offset:33280
    ds_read_b128 v[132:135], v176 offset:34304
    ds_read_b128 v[136:139], v177 offset:33280
    ds_read_b128 v[140:143], v178 offset:33280
    s_waitcnt lgkmcnt(4)
    s_waitcnt lgkmcnt(3)
    v_mfma_f32_32x32x16_bf16 v[64:79], v[128:131], v[4:7], v[48:63]
    s_waitcnt lgkmcnt(2)
    v_mfma_f32_32x32x16_bf16 v[80:95], v[132:135], v[8:11], 0
    s_add_u32 s89, s22, 0
    s_and_b32 s89, s89, 7
    s_mul_i32 s89, s89, 176128
    s_add_u32 s89, s89, s85
    s_add_u32 m0, s86, 0
    s_nop 0
    buffer_load_dwordx4 v232, s[12:15], s89 offen lds
    s_add_u32 m0, s86, 1024
    s_nop 0
    buffer_load_dwordx4 v233, s[12:15], s89 offen lds
    s_add_u32 m0, s86, 2048
    s_nop 0
    buffer_load_dwordx4 v234, s[12:15], s89 offen lds
L_poll_10:
    buffer_load_dword v15, v222, s[48:51], s69 offen sc1
    buffer_load_dwordx4 v[212:215], v1, s[48:51], s25 offen sc1
    s_waitcnt vmcnt(0)
    v_xor_b32 v15, s59, v15
    v_bitop3_b32 v15, v15, v212, s59 bitop3:0xf6
    v_bitop3_b32 v15, v15, v213, s59 bitop3:0xf6
    v_bitop3_b32 v15, v15, v214, s59 bitop3:0xf6
    v_bitop3_b32 v15, v15, v215, s59 bitop3:0xf6
    v_cmp_ne_u32 vcc, 0, v15
    s_cbranch_vccz L_polled_11
    s_cmp_eq_u32 s61, 0
    s_cbranch_scc1 L_polled_11
    s_sub_u32 s61, s61, 1
    s_sleep 1
    s_branch L_poll_10
L_polled_11:
    s_add_u32 m0, s52, 114944
    s_nop 0
    buffer_load_dwordx4 v1, s[48:51], s18 offen sc1 lds
    s_add_u32 m0, s52, 114944
    s_nop 0
    buffer_load_dwordx4 v1, s[48:51], s18 offen offset:1024 sc1 lds
    v_exp_f32 v64, v64
    ds_read_b128 v[128:131], v176 offset:38464
    v_exp_f32 v65, v65
    ds_read_b128 v[144:147], v179 offset:33280
    v_exp_f32 v66, v66
    ds_read_b128 v[148:151], v180 offset:33280
    v_exp_f32 v67, v67
    v_exp_f32 v68, v68
    s_add_u32 m0, s52, 114944
    v_exp_f32 v69, v69
    buffer_load_dwordx4 v1, s[48:51], s18 offen offset:2048 sc1 lds
    v_cvt_pk_bf16_f32 v160, v64, v65
    v_exp_f32 v70, v70
    v_exp_f32 v71, v71
    v_cvt_pk_bf16_f32 v161, v66, v67
    v_exp_f32 v72, v72
    v_exp_f32 v73, v73
    v_cvt_pk_bf16_f32 v162, v68, v69
    v_exp_f32 v74, v74
    v_exp_f32 v75, v75
    v_cvt_pk_bf16_f32 v163, v70, v71
    v_exp_f32 v76, v76
    s_add_u32 m0, s52, 114944
    v_exp_f32 v77, v77
    buffer_load_dwordx4 v1, s[48:51], s18 offen offset:3072 sc1 lds
    v_cvt_pk_bf16_f32 v164, v72, v73
    v_exp_f32 v78, v78
    s_waitcnt lgkmcnt(2)
    v_exp_f32 v79, v79
    v_cvt_pk_bf16_f32 v165, v74, v75
    v_cvt_pk_bf16_f32 v166, v76, v77
    v_cvt_pk_bf16_f32 v167, v78, v79
    v_mfma_f32_32x32x16_bf16 v[64:79], v[128:131], v[8:11], 0
    v_exp_f32 v80, v80
    ds_read_b128 v[132:135], v176 offset:42624
    v_exp_f32 v81, v81
    ds_read_b128 v[152:155], v179 offset:37440
    v_exp_f32 v82, v82
    ds_read_b128 v[156:159], v180 offset:37440
    v_exp_f32 v83, v83
    v_mfma_f32_32x32x16_bf16 v[96:111], v[136:139], v[160:163], 0
    v_exp_f32 v84, v84
    s_add_u32 m0, s52, 98304
    v_exp_f32 v85, v85
    buffer_load_dwordx4 v1, s[48:51], s19 offen sc1 lds
    v_cvt_pk_bf16_f32 v168, v80, v81
    v_exp_f32 v86, v86
    v_exp_f32 v87, v87
    v_cvt_pk_bf16_f32 v169, v82, v83
    v_exp_f32 v88, v88
    v_mfma_f32_32x32x16_bf16 v[96:111], v[140:143], v[164:167], v[96:111]
    v_exp_f32 v89, v89
    v_cvt_pk_bf16_f32 v170, v84, v85
    v_exp_f32 v90, v90
    v_exp_f32 v91, v91
    v_cvt_pk_bf16_f32 v171, v86, v87
    v_exp_f32 v92, v92
    s_add_u32 m0, s52, 98304
    v_exp_f32 v93, v93
    buffer_load_dwordx4 v1, s[48:51], s19 offen offset:1024 sc1 lds
    v_cvt_pk_bf16_f32 v172, v88, v89
    v_exp_f32 v94, v94
    s_waitcnt lgkmcnt(2)
    v_exp_f32 v95, v95
    v_cvt_pk_bf16_f32 v173, v90, v91
    v_cvt_pk_bf16_f32 v174, v92, v93
    v_cvt_pk_bf16_f32 v175, v94, v95
    v_mfma_f32_32x32x16_bf16 v[80:95], v[132:135], v[8:11], 0
    v_exp_f32 v64, v64
    ds_read_b128 v[128:131], v176 offset:46784
    v_exp_f32 v65, v65
    ds_read_b128 v[136:139], v179 offset:41600
    v_exp_f32 v66, v66
    ds_read_b128 v[140:143], v180 offset:41600
    v_exp_f32 v67, v67
    v_mfma_f32_32x32x16_bf16 v[112:127], v[144:147], v[168:171], 0
    v_exp_f32 v68, v68
    s_add_u32 m0, s52, 98304
    v_exp_f32 v69, v69
    buffer_load_dwordx4 v1, s[48:51], s19 offen offset:2048 sc1 lds
    v_cvt_pk_bf16_f32 v160, v64, v65
    v_exp_f32 v70, v70
    v_exp_f32 v71, v71
    v_cvt_pk_bf16_f32 v161, v66, v67
    v_exp_f32 v72, v72
    v_mfma_f32_32x32x16_bf16 v[112:127], v[148:151], v[172:175], v[112:127]
    v_exp_f32 v73, v73
    v_cvt_pk_bf16_f32 v162, v68, v69
    v_exp_f32 v74, v74
    v_exp_f32 v75, v75
    v_cvt_pk_bf16_f32 v163, v70, v71
    v_exp_f32 v76, v76
    s_add_u32 m0, s52, 98304
    v_exp_f32 v77, v77
    buffer_load_dwordx4 v1, s[48:51], s19 offen offset:3072 sc1 lds
    v_cvt_pk_bf16_f32 v164, v72, v73
    v_exp_f32 v78, v78
    s_waitcnt lgkmcnt(2)
    v_exp_f32 v79, v79
    v_cvt_pk_bf16_f32 v165, v74, v75
    v_cvt_pk_bf16_f32 v166, v76, v77
    v_cvt_pk_bf16_f32 v167, v78, v79
    v_mfma_f32_32x32x16_bf16 v[64:79], v[128:131], v[8:11], v[48:63]
    v_exp_f32 v80, v80
    v_exp_f32 v81, v81
    ds_read_b128 v[144:147], v179 offset:45760
    v_exp_f32 v82, v82
    ds_read_b128 v[148:151], v180 offset:45760
    v_exp_f32 v83, v83
    v_mfma_f32_32x32x16_bf16 v[112:127], v[152:155], v[160:163], v[112:127]
    v_exp_f32 v84, v84
    s_mov_b64 exec, 2
    buffer_store_dword v14, v13, s[48:51], s64 offen sc1
    s_mov_b64 exec, -1
    v_exp_f32 v85, v85
    v_cvt_pk_bf16_f32 v168, v80, v81
    v_exp_f32 v86, v86
    v_exp_f32 v87, v87
    v_cvt_pk_bf16_f32 v169, v82, v83
    v_exp_f32 v88, v88
    v_mfma_f32_32x32x16_bf16 v[112:127], v[156:159], v[164:167], v[112:127]
    v_exp_f32 v89, v89
    v_cvt_pk_bf16_f32 v170, v84, v85
    v_exp_f32 v90, v90
    v_exp_f32 v91, v91
    v_cvt_pk_bf16_f32 v171, v86, v87
    v_exp_f32 v92, v92
    v_exp_f32 v93, v93
    v_cvt_pk_bf16_f32 v172, v88, v89
    v_exp_f32 v94, v94
    v_exp_f32 v95, v95
    v_cvt_pk_bf16_f32 v173, v90, v91
    v_cvt_pk_bf16_f32 v174, v92, v93
    v_cvt_pk_bf16_f32 v175, v94, v95
    v_exp_f32 v64, v64
    v_exp_f32 v65, v65
    v_exp_f32 v66, v66
    v_exp_f32 v67, v67
    s_waitcnt lgkmcnt(2)
    v_mfma_f32_32x32x16_bf16 v[112:127], v[136:139], v[168:171], v[112:127]
    v_exp_f32 v68, v68
    v_exp_f32 v69, v69
    buffer_load_dwordx4 a[0:3], v1, s[48:51], s83 offen sc1
    v_cvt_pk_bf16_f32 v160, v64, v65
    v_exp_f32 v70, v70
    v_exp_f32 v71, v71
    v_cvt_pk_bf16_f32 v161, v66, v67
    v_exp_f32 v72, v72
    v_mfma_f32_32x32x16_bf16 v[112:127], v[140:143], v[172:175], v[112:127]
    s_waitcnt vmcnt(6)
    s_barrier
    ds_read_b128 v[132:135], v176 offset:16640
    ds_read_b128 v[128:131], v176 offset:20800
    ds_read_b128 v[152:155], v177 offset:16640
    ds_read_b128 v[156:159], v178 offset:16640
    v_exp_f32 v73, v73
    v_cvt_pk_bf16_f32 v162, v68, v69
    v_exp_f32 v74, v74
    v_exp_f32 v75, v75
    v_cvt_pk_bf16_f32 v163, v70, v71
    v_exp_f32 v76, v76
    v_exp_f32 v77, v77
    v_cvt_pk_bf16_f32 v164, v72, v73
    v_exp_f32 v78, v78
    v_exp_f32 v79, v79
    v_cvt_pk_bf16_f32 v165, v74, v75
    s_waitcnt lgkmcnt(3)
    v_mfma_f32_32x32x16_bf16 v[80:95], v[132:135], v[4:7], 0
    v_cvt_pk_bf16_f32 v166, v76, v77
    v_cvt_pk_bf16_f32 v167, v78, v79
    s_waitcnt lgkmcnt(2)
    v_mfma_f32_32x32x16_bf16 v[64:79], v[128:131], v[4:7], 0
    s_nop 7
    v_exp_f32 v80, v80
    ds_read_b128 v[132:135], v176 offset:24960
    v_exp_f32 v81, v81
    ds_read_b128 v[136:139], v177 offset:20800
    v_exp_f32 v82, v82
    ds_read_b128 v[140:143], v178 offset:20800
    v_exp_f32 v83, v83
    v_mfma_f32_32x32x16_bf16 v[112:127], v[144:147], v[160:163], v[112:127]
    v_exp_f32 v84, v84
    v_exp_f32 v85, v85
    buffer_load_dwordx4 a[32:35], v1, s[48:51], s90 offen sc1
    v_cvt_pk_bf16_f32 v168, v80, v81
    v_exp_f32 v86, v86
    v_exp_f32 v87, v87
    buffer_load_dwordx4 a[4:7], v1, s[48:51], s83 offen offset:1024 sc1
    v_cvt_pk_bf16_f32 v169, v82, v83
    v_exp_f32 v88, v88
    v_mfma_f32_32x32x16_bf16 v[112:127], v[148:151], v[164:167], v[112:127]
    v_exp_f32 v89, v89
    buffer_load_dwordx4 a[36:39], v1, s[48:51], s90 offen offset:1024 sc1
    v_cvt_pk_bf16_f32 v170, v84, v85
    v_exp_f32 v90, v90
    v_exp_f32 v91, v91
    v_cvt_pk_bf16_f32 v171, v86, v87
    v_exp_f32 v92, v92
    s_add_u32 s89, s22, 1
    s_and_b32 s89, s89, 7
    s_mul_i32 s89, s89, 176128
    s_add_u32 s89, s89, s85
    s_add_u32 m0, s86, 12288
    v_exp_f32 v93, v93
    buffer_load_dwordx4 v232, s[12:15], s89 offen lds
    v_cvt_pk_bf16_f32 v172, v88, v89
    v_exp_f32 v94, v94
    s_waitcnt lgkmcnt(2)
    v_exp_f32 v95, v95
    v_cvt_pk_bf16_f32 v173, v90, v91
    v_cvt_pk_bf16_f32 v174, v92, v93
    v_cvt_pk_bf16_f32 v175, v94, v95
    v_mfma_f32_32x32x16_bf16 v[80:95], v[132:135], v[4:7], 0
    v_exp_f32 v64, v64
    ds_read_b128 v[128:131], v176 offset:29120
    v_exp_f32 v65, v65
    ds_read_b128 v[144:147], v177 offset:24960
    v_exp_f32 v66, v66
    ds_read_b128 v[148:151], v178 offset:24960
    v_exp_f32 v67, v67
    v_mfma_f32_32x32x16_bf16 v[96:111], v[152:155], v[168:171], v[96:111]
    v_exp_f32 v68, v68
    v_exp_f32 v69, v69
    buffer_load_dwordx4 a[8:11], v1, s[48:51], s83 offen offset:2048 sc1
    v_cvt_pk_bf16_f32 v160, v64, v65
    v_exp_f32 v70, v70
    s_add_u32 m0, s86, 13312
    v_exp_f32 v71, v71
    buffer_load_dwordx4 v233, s[12:15], s89 offen lds
    v_cvt_pk_bf16_f32 v161, v66, v67
    v_exp_f32 v72, v72
    v_mfma_f32_32x32x16_bf16 v[96:111], v[156:159], v[172:175], v[96:111]
    v_exp_f32 v73, v73
    buffer_load_dwordx4 a[40:43], v1, s[48:51], s90 offen offset:2048 sc1
    v_cvt_pk_bf16_f32 v162, v68, v69
    v_exp_f32 v74, v74
    v_exp_f32 v75, v75
    v_cvt_pk_bf16_f32 v163, v70, v71
    v_exp_f32 v76, v76
    s_add_u32 m0, s86, 14336
    v_exp_f32 v77, v77
    buffer_load_dwordx4 v234, s[12:15], s89 offen lds
    v_cvt_pk_bf16_f32 v164, v72, v73
    v_exp_f32 v78, v78
    s_waitcnt lgkmcnt(2)
    v_exp_f32 v79, v79
    v_cvt_pk_bf16_f32 v165, v74, v75
    v_cvt_pk_bf16_f32 v166, v76, v77
    v_cvt_pk_bf16_f32 v167, v78, v79
    v_mfma_f32_32x32x16_bf16 v[64:79], v[128:131], v[4:7], 0
    v_exp_f32 v80, v80
    ds_read_b128 v[132:135], v176 offset:17664
    v_exp_f32 v81, v81
    ds_read_b128 v[152:155], v177 offset:29120
    v_exp_f32 v82, v82
    ds_read_b128 v[156:159], v178 offset:29120
    v_exp_f32 v83, v83
    v_mfma_f32_32x32x16_bf16 v[96:111], v[136:139], v[160:163], v[96:111]
    v_exp_f32 v84, v84
    v_exp_f32 v85, v85
    buffer_load_dwordx4 a[12:15], v1, s[48:51], s83 offen offset:3072 sc1
    v_cvt_pk_bf16_f32 v168, v80, v81
    v_exp_f32 v86, v86
    v_exp_f32 v87, v87
    buffer_load_dwordx4 v[212:215], v1, s[48:51], s74 offen sc1
    v_cvt_pk_bf16_f32 v169, v82, v83
    v_exp_f32 v88, v88
    s_add_u32 s89, s22, 2
    s_and_b32 s89, s89, 7
    s_mul_i32 s89, s89, 176128
    s_add_u32 s89, s89, s85
    s_add_u32 m0, s86, 24576
    v_mfma_f32_32x32x16_bf16 v[96:111], v[140:143], v[164:167], v[96:111]
    v_exp_f32 v89, v89
    buffer_load_dwordx4 v232, s[12:15], s89 offen lds
    v_cvt_pk_bf16_f32 v170, v84, v85
    v_exp_f32 v90, v90
    v_exp_f32 v91, v91
    v_cvt_pk_bf16_f32 v171, v86, v87
    v_exp_f32 v92, v92
    v_exp_f32 v93, v93
    buffer_load_dwordx4 a[44:47], v1, s[48:51], s90 offen offset:3072 sc1
    v_cvt_pk_bf16_f32 v172, v88, v89
    v_exp_f32 v94, v94
    s_waitcnt lgkmcnt(2)
    v_exp_f32 v95, v95
    v_cvt_pk_bf16_f32 v173, v90, v91
    v_cvt_pk_bf16_f32 v174, v92, v93
    v_cvt_pk_bf16_f32 v175, v94, v95
    v_mfma_f32_32x32x16_bf16 v[80:95], v[132:135], v[8:11], 0
    v_exp_f32 v64, v64
    ds_read_b128 v[128:131], v176 offset:21824
    v_exp_f32 v65, v65
    ds_read_b128 v[136:139], v179 offset:16640
    v_exp_f32 v66, v66
    ds_read_b128 v[140:143], v180 offset:16640
    v_exp_f32 v67, v67
    v_mfma_f32_32x32x16_bf16 v[96:111], v[144:147], v[168:171], v[96:111]
    v_exp_f32 v68, v68
    s_add_u32 m0, s86, 25600
    v_exp_f32 v69, v69
    buffer_load_dwordx4 v233, s[12:15], s89 offen lds
    v_cvt_pk_bf16_f32 v160, v64, v65
    v_exp_f32 v70, v70
    v_exp_f32 v71, v71
    v_cvt_pk_bf16_f32 v161, v66, v67
    v_exp_f32 v72, v72
    s_add_u32 s83, s83, 4096
    v_mfma_f32_32x32x16_bf16 v[96:111], v[148:151], v[172:175], v[96:111]
    v_exp_f32 v73, v73
    buffer_load_dwordx4 a[16:19], v1, s[48:51], s83 offen sc1
    v_cvt_pk_bf16_f32 v162, v68, v69
    v_exp_f32 v74, v74
    v_exp_f32 v75, v75
    v_cvt_pk_bf16_f32 v163, v70, v71
    v_exp_f32 v76, v76
    s_add_u32 m0, s86, 26624
    v_exp_f32 v77, v77
    buffer_load_dwordx4 v234, s[12:15], s89 offen lds
    v_cvt_pk_bf16_f32 v164, v72, v73
    v_exp_f32 v78, v78
    s_waitcnt lgkmcnt(2)
    v_exp_f32 v79, v79
    v_cvt_pk_bf16_f32 v165, v74, v75
    v_cvt_pk_bf16_f32 v166, v76, v77
    v_cvt_pk_bf16_f32 v167, v78, v79
    v_mfma_f32_32x32x16_bf16 v[64:79], v[128:131], v[8:11], 0
    v_exp_f32 v80, v80
    ds_read_b128 v[132:135], v176 offset:25984
    v_exp_f32 v81, v81
    ds_read_b128 v[144:147], v179 offset:20800
    v_exp_f32 v82, v82
    ds_read_b128 v[148:151], v180 offset:20800
    v_exp_f32 v83, v83
    v_mfma_f32_32x32x16_bf16 v[96:111], v[152:155], v[160:163], v[96:111]
    v_exp_f32 v84, v84
    s_add_u32 s90, s90, 4096
    v_exp_f32 v85, v85
    buffer_load_dwordx4 a[48:51], v1, s[48:51], s90 offen sc1
    v_cvt_pk_bf16_f32 v168, v80, v81
    v_exp_f32 v86, v86
    v_exp_f32 v87, v87
    v_cvt_pk_bf16_f32 v169, v82, v83
    v_exp_f32 v88, v88
    s_add_u32 s89, s22, 3
    s_and_b32 s89, s89, 7
    s_mul_i32 s89, s89, 176128
    s_add_u32 s89, s89, s85
    s_add_u32 m0, s86, 36864
    v_mfma_f32_32x32x16_bf16 v[96:111], v[156:159], v[164:167], v[96:111]
    v_exp_f32 v89, v89
    buffer_load_dwordx4 v232, s[12:15], s89 offen lds
    v_cvt_pk_bf16_f32 v170, v84, v85
    v_exp_f32 v90, v90
    v_exp_f32 v91, v91
    v_cvt_pk_bf16_f32 v171, v86, v87
    v_exp_f32 v92, v92
    v_exp_f32 v93, v93
    buffer_load_dwordx4 a[20:23], v1, s[48:51], s83 offen offset:1024 sc1
    v_cvt_pk_bf16_f32 v172, v88, v89
    v_exp_f32 v94, v94
    s_waitcnt lgkmcnt(2)
    v_exp_f32 v95, v95
    v_cvt_pk_bf16_f32 v173, v90, v91
    v_cvt_pk_bf16_f32 v174, v92, v93
    v_cvt_pk_bf16_f32 v175, v94, v95
    v_mfma_f32_32x32x16_bf16 v[80:95], v[132:135], v[8:11], 0
    v_exp_f32 v64, v64
    ds_read_b128 v[128:131], v176 offset:30144
    v_exp_f32 v65, v65
    ds_read_b128 v[152:155], v179 offset:24960
    v_exp_f32 v66, v66
    ds_read_b128 v[156:159], v180 offset:24960
    v_exp_f32 v67, v67
    v_mfma_f32_32x32x16_bf16 v[112:127], v[136:139], v[168:171], v[112:127]
    v_exp_f32 v68, v68
    s_add_u32 m0, s86, 37888
    v_exp_f32 v69, v69
    buffer_load_dwordx4 v233, s[12:15], s89 offen lds
    v_cvt_pk_bf16_f32 v160, v64, v65
    v_exp_f32 v70, v70
    v_exp_f32 v71, v71
    v_cvt_pk_bf16_f32 v161, v66, v67
    v_exp_f32 v72, v72
    v_mfma_f32_32x32x16_bf16 v[112:127], v[140:143], v[172:175], v[112:127]
    v_exp_f32 v73, v73
    buffer_load_dwordx4 a[52:55], v1, s[48:51], s90 offen offset:1024 sc1
    v_cvt_pk_bf16_f32 v162, v68, v69
    v_exp_f32 v74, v74
    v_exp_f32 v75, v75
    v_cvt_pk_bf16_f32 v163, v70, v71
    v_exp_f32 v76, v76
    s_add_u32 m0, s86, 38912
    v_exp_f32 v77, v77
    buffer_load_dwordx4 v234, s[12:15], s89 offen lds
    v_cvt_pk_bf16_f32 v164, v72, v73
    v_exp_f32 v78, v78
    s_waitcnt lgkmcnt(2)
    v_exp_f32 v79, v79
    v_cvt_pk_bf16_f32 v165, v74, v75
    v_cvt_pk_bf16_f32 v166, v76, v77
    v_cvt_pk_bf16_f32 v167, v78, v79
    v_mfma_f32_32x32x16_bf16 v[64:79], v[128:131], v[8:11], 0
    v_exp_f32 v80, v80
    v_exp_f32 v81, v81
    ds_read_b128 v[136:139], v179 offset:29120
    v_exp_f32 v82, v82
    ds_read_b128 v[140:143], v180 offset:29120
    v_exp_f32 v83, v83
    v_mfma_f32_32x32x16_bf16 v[112:127], v[144:147], v[160:163], v[112:127]
    v_exp_f32 v84, v84
    v_exp_f32 v85, v85
    buffer_load_dwordx4 a[24:27], v1, s[48:51], s83 offen offset:2048 sc1
    v_cvt_pk_bf16_f32 v168, v80, v81
    v_exp_f32 v86, v86
    v_exp_f32 v87, v87
    v_cvt_pk_bf16_f32 v169, v82, v83
    v_exp_f32 v88, v88
    s_waitcnt vmcnt(12)
    v_xor_b32 v231, s59, v212
    v_bitop3_b32 v231, v231, v213, s59 bitop3:0xf6
    v_bitop3_b32 v231, v231, v214, s59 bitop3:0xf6
    v_bitop3_b32 v231, v231, v215, s59 bitop3:0xf6
    v_cmp_ne_u32 vcc, 0, v231
    s_cbranch_vccz L_seen_12
L_poll_13:
    buffer_load_dwordx4 v[212:215], v1, s[48:51], s74 offen sc1
    s_waitcnt vmcnt(0)
    v_xor_b32 v231, s59, v212
    v_bitop3_b32 v231, v231, v213, s59 bitop3:0xf6
    v_bitop3_b32 v231, v231, v214, s59 bitop3:0xf6
    v_bitop3_b32 v231, v231, v215, s59 bitop3:0xf6
    v_cmp_ne_u32 vcc, 0, v231
    s_cbranch_vccz L_polled_14
    s_cmp_eq_u32 s61, 0
    s_cbranch_scc1 L_polled_14
    s_sub_u32 s61, s61, 1
    s_sleep 4
    s_branch L_poll_13
L_polled_14:
L_seen_12:
    v_mfma_f32_32x32x16_bf16 v[112:127], v[148:151], v[164:167], v[112:127]
    v_exp_f32 v89, v89
    v_cvt_pk_bf16_f32 v170, v84, v85
    v_exp_f32 v90, v90
    v_exp_f32 v91, v91
    v_cvt_pk_bf16_f32 v171, v86, v87
    v_exp_f32 v92, v92
    s_mov_b32 s3, 65536
    v_exp_f32 v93, v93
    buffer_load_dwordx4 v[212:215], v230, s[48:51], s3 offen sc1
    v_cvt_pk_bf16_f32 v172, v88, v89
    v_exp_f32 v94, v94
    v_exp_f32 v95, v95
    v_cvt_pk_bf16_f32 v173, v90, v91
    v_cvt_pk_bf16_f32 v174, v92, v93
    v_cvt_pk_bf16_f32 v175, v94, v95
    v_exp_f32 v64, v64
    v_exp_f32 v65, v65
    v_exp_f32 v66, v66
    v_exp_f32 v67, v67
    s_waitcnt lgkmcnt(2)
    v_mfma_f32_32x32x16_bf16 v[112:127], v[152:155], v[168:171], v[112:127]
    v_exp_f32 v68, v68
    s_mov_b32 s3, 73728
    v_exp_f32 v69, v69
    buffer_load_dwordx4 v[216:219], v230, s[48:51], s3 offen sc1
    v_cvt_pk_bf16_f32 v160, v64, v65
    v_exp_f32 v70, v70
    v_exp_f32 v71, v71
    v_cvt_pk_bf16_f32 v161, v66, v67
    v_exp_f32 v72, v72
    s_mov_b32 s3, 81920
    v_mfma_f32_32x32x16_bf16 v[112:127], v[156:159], v[172:175], v[112:127]
    buffer_load_dwordx4 v[220:223], v230, s[48:51], s3 offen sc1
    s_barrier
    ds_read_b128 v[132:135], v176 offset:0
    ds_read_b128 v[128:131], v176 offset:4160
    ds_read_b128 v[144:147], v177 offset:0
    ds_read_b128 v[148:151], v178 offset:0
    v_exp_f32 v73, v73
    v_cvt_pk_bf16_f32 v162, v68, v69
    v_exp_f32 v74, v74
    v_exp_f32 v75, v75
    v_cvt_pk_bf16_f32 v163, v70, v71
    v_exp_f32 v76, v76
    s_mov_b32 s3, 90112
    v_exp_f32 v77, v77
    buffer_load_dwordx4 v[224:227], v230, s[48:51], s3 offen sc1
    v_cvt_pk_bf16_f32 v164, v72, v73
    v_exp_f32 v78, v78
    v_exp_f32 v79, v79
    v_cvt_pk_bf16_f32 v165, v74, v75
    s_waitcnt lgkmcnt(3)
    v_mfma_f32_32x32x16_bf16 v[80:95], v[132:135], v[4:7], v[16:31]
    v_cvt_pk_bf16_f32 v166, v76, v77
    v_cvt_pk_bf16_f32 v167, v78, v79
    s_waitcnt lgkmcnt(2)
    v_mfma_f32_32x32x16_bf16 v[64:79], v[128:131], v[4:7], 0
    s_nop 7
    v_exp_f32 v80, v80
    ds_read_b128 v[132:135], v176 offset:8320
    v_exp_f32 v81, v81
    ds_read_b128 v[152:155], v177 offset:4160
    v_exp_f32 v82, v82
    ds_read_b128 v[156:159], v178 offset:4160
    v_exp_f32 v83, v83
    v_mfma_f32_32x32x16_bf16 v[112:127], v[136:139], v[160:163], v[112:127]
    v_exp_f32 v84, v84
    s_add_u32 s89, s22, 4
    s_and_b32 s89, s89, 7
    s_mul_i32 s89, s89, 176128
    s_add_u32 s89, s89, s85
    s_add_u32 m0, s86, 49152
    v_exp_f32 v85, v85
    buffer_load_dwordx4 v232, s[12:15], s89 offen lds
    v_cvt_pk_bf16_f32 v168, v80, v81
    v_exp_f32 v86, v86
    v_exp_f32 v87, v87
    v_cvt_pk_bf16_f32 v169, v82, v83
    v_exp_f32 v88, v88
    v_mfma_f32_32x32x16_bf16 v[112:127], v[140:143], v[164:167], v[112:127]
    v_exp_f32 v89, v89
    buffer_load_dwordx4 a[56:59], v1, s[48:51], s90 offen offset:2048 sc1
    v_cvt_pk_bf16_f32 v170, v84, v85
    v_exp_f32 v90, v90
    v_exp_f32 v91, v91
    v_cvt_pk_bf16_f32 v171, v86, v87
    v_exp_f32 v92, v92
    s_add_u32 m0, s86, 50176
    v_exp_f32 v93, v93
    buffer_load_dwordx4 v233, s[12:15], s89 offen lds
    v_cvt_pk_bf16_f32 v172, v88, v89
    v_exp_f32 v94, v94
    s_waitcnt lgkmcnt(2)
    v_exp_f32 v95, v95
    v_cvt_pk_bf16_f32 v173, v90, v91
    v_cvt_pk_bf16_f32 v174, v92, v93
    v_cvt_pk_bf16_f32 v175, v94, v95
    v_mfma_f32_32x32x16_bf16 v[80:95], v[132:135], v[4:7], 0
    v_exp_f32 v64, v64
    ds_read_b128 v[128:131], v176 offset:12480
    v_exp_f32 v65, v65
    ds_read_b128 v[136:139], v177 offset:8320
    v_exp_f32 v66, v66
    ds_read_b128 v[140:143], v178 offset:8320
    v_exp_f32 v67, v67
    v_mfma_f32_32x32x16_bf16 v[96:111], v[144:147], v[168:171], v[96:111]
    v_exp_f32 v68, v68
    v_exp_f32 v69, v69
    buffer_load_dwordx4 a[28:31], v1, s[48:51], s83 offen offset:3072 sc1
    v_cvt_pk_bf16_f32 v160, v64, v65
    v_exp_f32 v70, v70
    v_exp_f32 v71, v71
    v_cvt_pk_bf16_f32 v161, v66, v67
    v_exp_f32 v72, v72
    s_add_u32 m0, s86, 51200
    v_mfma_f32_32x32x16_bf16 v[96:111], v[148:151], v[172:175], v[96:111]
    v_exp_f32 v73, v73
    buffer_load_dwordx4 v234, s[12:15], s89 offen lds
    v_cvt_pk_bf16_f32 v162, v68, v69
    v_exp_f32 v74, v74
    v_exp_f32 v75, v75
    v_cvt_pk_bf16_f32 v163, v70, v71
    v_exp_f32 v76, v76
    v_exp_f32 v77, v77
    buffer_load_dwordx4 a[60:63], v1, s[48:51], s90 offen offset:3072 sc1
    v_cvt_pk_bf16_f32 v164, v72, v73
    v_exp_f32 v78, v78
    s_waitcnt lgkmcnt(2)
    v_exp_f32 v79, v79
    v_cvt_pk_bf16_f32 v165, v74, v75
    v_cvt_pk_bf16_f32 v166, v76, v77
    v_cvt_pk_bf16_f32 v167, v78, v79
    v_mfma_f32_32x32x16_bf16 v[64:79], v[128:131], v[4:7], 0
    v_exp_f32 v80, v80
    ds_read_b128 v[132:135], v176 offset:13504
    v_exp_f32 v81, v81
    ds_read_b128 v[144:147], v177 offset:12480
    v_exp_f32 v82, v82
    ds_read_b128 v[148:151], v178 offset:12480
    v_exp_f32 v83, v83
    v_mfma_f32_32x32x16_bf16 v[96:111], v[152:155], v[160:163], v[96:111]
    v_exp_f32 v84, v84
    s_add_u32 s89, s22, 5
    s_and_b32 s89, s89, 7
    s_mul_i32 s89, s89, 176128
    s_add_u32 s89, s89, s85
    s_add_u32 m0, s86, 61440
    v_exp_f32 v85, v85
    buffer_load_dwordx4 v232, s[12:15], s89 offen lds
    v_cvt_pk_bf16_f32 v168, v80, v81
    v_exp_f32 v86, v86
    v_exp_f32 v87, v87
    v_cvt_pk_bf16_f32 v169, v82, v83
    v_exp_f32 v88, v88
    s_add_u32 m0, s86, 62464
    v_mfma_f32_32x32x16_bf16 v[96:111], v[156:159], v[164:167], v[96:111]
    v_exp_f32 v89, v89
    buffer_load_dwordx4 v233, s[12:15], s89 offen lds
    v_cvt_pk_bf16_f32 v170, v84, v85
    v_exp_f32 v90, v90
    v_exp_f32 v91, v91
    v_cvt_pk_bf16_f32 v171, v86, v87
    v_exp_f32 v92, v92
    s_add_u32 m0, s86, 63488
    v_exp_f32 v93, v93
    buffer_load_dwordx4 v234, s[12:15], s89 offen lds
    v_cvt_pk_bf16_f32 v172, v88, v89
    v_exp_f32 v94, v94
    s_waitcnt lgkmcnt(2)
    v_exp_f32 v95, v95
    v_cvt_pk_bf16_f32 v173, v90, v91
    v_cvt_pk_bf16_f32 v174, v92, v93
    v_cvt_pk_bf16_f32 v175, v94, v95
    v_mfma_f32_32x32x16_bf16 v[80:95], v[132:135], v[8:11], v[16:31]
    v_exp_f32 v64, v64
    v_exp_f32 v65, v65
    ds_read_b128 v[152:155], v179 offset:12480
    v_exp_f32 v66, v66
    ds_read_b128 v[156:159], v180 offset:12480
    v_exp_f32 v67, v67
    v_mfma_f32_32x32x16_bf16 v[96:111], v[136:139], v[168:171], v[96:111]
    v_exp_f32 v68, v68
    v_exp_f32 v69, v69
    buffer_load_dwordx4 a[64:67], v1, s[48:51], s84 offen sc1
    v_cvt_pk_bf16_f32 v160, v64, v65
    v_exp_f32 v70, v70
    v_exp_f32 v71, v71
    v_cvt_pk_bf16_f32 v161, v66, v67
    v_exp_f32 v72, v72
    v_mfma_f32_32x32x16_bf16 v[96:111], v[140:143], v[172:175], v[96:111]
    v_exp_f32 v73, v73
    buffer_load_dwordx4 a[152:155], v1, s[48:51], s91 offen sc1
    v_cvt_pk_bf16_f32 v162, v68, v69
    v_exp_f32 v74, v74
    v_exp_f32 v75, v75
    v_cvt_pk_bf16_f32 v163, v70, v71
    v_exp_f32 v76, v76
    v_exp_f32 v77, v77
    buffer_load_dwordx4 a[68:71], v1, s[48:51], s84 offen offset:1024 sc1
    v_cvt_pk_bf16_f32 v164, v72, v73
    v_exp_f32 v78, v78
    v_exp_f32 v79, v79
    v_cvt_pk_bf16_f32 v165, v74, v75
    v_cvt_pk_bf16_f32 v166, v76, v77
    v_cvt_pk_bf16_f32 v167, v78, v79
    v_exp_f32 v80, v80
    v_exp_f32 v81, v81
    v_exp_f32 v82, v82
    v_exp_f32 v83, v83
    s_waitcnt lgkmcnt(2)
    v_mfma_f32_32x32x16_bf16 v[96:111], v[144:147], v[160:163], v[96:111]
    v_exp_f32 v84, v84
    v_exp_f32 v85, v85
    v_cvt_pk_bf16_f32 v168, v80, v81
    v_exp_f32 v86, v86
    v_exp_f32 v87, v87
    v_cvt_pk_bf16_f32 v169, v82, v83
    v_exp_f32 v88, v88
    v_mfma_f32_32x32x16_bf16 v[96:111], v[148:151], v[164:167], v[96:111]
    v_exp_f32 v89, v89
    v_cvt_pk_bf16_f32 v170, v84, v85
    v_exp_f32 v90, v90
    v_exp_f32 v91, v91
    v_cvt_pk_bf16_f32 v171, v86, v87
    v_exp_f32 v92, v92
    v_exp_f32 v93, v93
    v_cvt_pk_bf16_f32 v172, v88, v89
    v_exp_f32 v94, v94
    v_exp_f32 v95, v95
    v_cvt_pk_bf16_f32 v173, v90, v91
    v_cvt_pk_bf16_f32 v174, v92, v93
    v_cvt_pk_bf16_f32 v175, v94, v95
    s_waitcnt lgkmcnt(0)
    v_mfma_f32_32x32x16_bf16 v[112:127], v[152:155], v[168:171], v[112:127]
    v_mfma_f32_32x32x16_bf16 v[112:127], v[156:159], v[172:175], v[112:127]
    s_branch L_att_done
L_att1:
    ds_read_b128 v[128:131], v176 offset:33280
    ds_read_b128 v[132:135], v176 offset:37440
    ds_read_b128 v[136:139], v177 offset:33280
    ds_read_b128 v[140:143], v178 offset:33280
    s_waitcnt lgkmcnt(4)
    s_waitcnt lgkmcnt(3)
    v_mfma_f32_32x32x16_bf16 v[64:79], v[128:131], v[4:7], 0
    s_waitcnt lgkmcnt(2)
    v_mfma_f32_32x32x16_bf16 v[80:95], v[132:135], v[4:7], v[48:63]
    s_add_u32 s89, s22, 0
    s_and_b32 s89, s89, 7
    s_mul_i32 s89, s89, 176128
    s_add_u32 s89, s89, s85
    s_add_u32 m0, s86, 0
    s_nop 0
    buffer_load_dwordx4 v232, s[12:15], s89 offen lds
    s_add_u32 m0, s86, 1024
    s_nop 0
    buffer_load_dwordx4 v233, s[12:15], s89 offen lds
    s_add_u32 m0, s86, 2048
    s_nop 0
    buffer_load_dwordx4 v234, s[12:15], s89 offen lds
L_poll_15:
    buffer_load_dword v15, v222, s[48:51], s69 offen sc1
    buffer_load_dwordx4 v[212:215], v1, s[48:51], s25 offen sc1
    s_waitcnt vmcnt(0)
    v_xor_b32 v15, s59, v15
    v_bitop3_b32 v15, v15, v212, s59 bitop3:0xf6
    v_bitop3_b32 v15, v15, v213, s59 bitop3:0xf6
    v_bitop3_b32 v15, v15, v214, s59 bitop3:0xf6
    v_bitop3_b32 v15, v15, v215, s59 bitop3:0xf6
    v_cmp_ne_u32 vcc, 0, v15
    s_cbranch_vccz L_polled_16
    s_cmp_eq_u32 s61, 0
    s_cbranch_scc1 L_polled_16
    s_sub_u32 s61, s61, 1
    s_sleep 1
    s_branch L_poll_15
L_polled_16:
    s_add_u32 m0, s52, 114944
    s_nop 0
    buffer_load_dwordx4 v1, s[48:51], s18 offen sc1 lds
    s_add_u32 m0, s52, 114944
    s_nop 0
    buffer_load_dwordx4 v1, s[48:51], s18 offen offset:1024 sc1 lds
    v_exp_f32 v64, v64
    ds_read_b128 v[128:131], v176 offset:34304
    v_exp_f32 v65, v65
    ds_read_b128 v[144:147], v177 offset:37440
    v_exp_f32 v66, v66
    ds_read_b128 v[148:151], v178 offset:37440
    v_exp_f32 v67, v67
    v_exp_f32 v68, v68
    s_add_u32 m0, s52, 114944
    v_exp_f32 v69, v69
    buffer_load_dwordx4 v1, s[48:51], s18 offen offset:2048 sc1 lds
    v_cvt_pk_bf16_f32 v160, v64, v65
    v_exp_f32 v70, v70
    v_exp_f32 v71, v71
    v_cvt_pk_bf16_f32 v161, v66, v67
    v_exp_f32 v72, v72
    v_exp_f32 v73, v73
    v_cvt_pk_bf16_f32 v162, v68, v69
    v_exp_f32 v74, v74
    v_exp_f32 v75, v75
    v_cvt_pk_bf16_f32 v163, v70, v71
    v_exp_f32 v76, v76
    s_add_u32 m0, s52, 114944
    v_exp_f32 v77, v77
    buffer_load_dwordx4 v1, s[48:51], s18 offen offset:3072 sc1 lds
    v_cvt_pk_bf16_f32 v164, v72, v73
    v_exp_f32 v78, v78
    s_waitcnt lgkmcnt(2)
    v_exp_f32 v79, v79
    v_cvt_pk_bf16_f32 v165, v74, v75
    v_cvt_pk_bf16_f32 v166, v76, v77
    v_cvt_pk_bf16_f32 v167, v78, v79
    v_mfma_f32_32x32x16_bf16 v[64:79], v[128:131], v[8:11], 0
    v_exp_f32 v80, v80
    ds_read_b128 v[132:135], v176 offset:38464
    v_exp_f32 v81, v81
    ds_read_b128 v[152:155], v179 offset:33280
    v_exp_f32 v82, v82
    ds_read_b128 v[156:159], v180 offset:33280
    v_exp_f32 v83, v83
    v_mfma_f32_32x32x16_bf16 v[96:111], v[136:139], v[160:163], 0
    v_exp_f32 v84, v84
    s_add_u32 m0, s52, 98304
    v_exp_f32 v85, v85
    buffer_load_dwordx4 v1, s[48:51], s19 offen sc1 lds
    v_cvt_pk_bf16_f32 v168, v80, v81
    v_exp_f32 v86, v86
    v_exp_f32 v87, v87
    v_cvt_pk_bf16_f32 v169, v82, v83
    v_exp_f32 v88, v88
    v_mfma_f32_32x32x16_bf16 v[96:111], v[140:143], v[164:167], v[96:111]
    v_exp_f32 v89, v89
    v_cvt_pk_bf16_f32 v170, v84, v85
    v_exp_f32 v90, v90
    v_exp_f32 v91, v91
    v_cvt_pk_bf16_f32 v171, v86, v87
    v_exp_f32 v92, v92
    s_add_u32 m0, s52, 98304
    v_exp_f32 v93, v93
    buffer_load_dwordx4 v1, s[48:51], s19 offen offset:1024 sc1 lds
    v_cvt_pk_bf16_f32 v172, v88, v89
    v_exp_f32 v94, v94
    s_waitcnt lgkmcnt(2)
    v_exp_f32 v95, v95
    v_cvt_pk_bf16_f32 v173, v90, v91
    v_cvt_pk_bf16_f32 v174, v92, v93
    v_cvt_pk_bf16_f32 v175, v94, v95
    v_mfma_f32_32x32x16_bf16 v[80:95], v[132:135], v[8:11], 0
    v_exp_f32 v64, v64
    ds_read_b128 v[128:131], v176 offset:42624
    v_exp_f32 v65, v65
    ds_read_b128 v[136:139], v179 offset:37440
    v_exp_f32 v66, v66
    ds_read_b128 v[140:143], v180 offset:37440
    v_exp_f32 v67, v67
    v_mfma_f32_32x32x16_bf16 v[96:111], v[144:147], v[168:171], v[96:111]
    v_exp_f32 v68, v68
    s_add_u32 m0, s52, 98304
    v_exp_f32 v69, v69
    buffer_load_dwordx4 v1, s[48:51], s19 offen offset:2048 sc1 lds
    v_cvt_pk_bf16_f32 v160, v64, v65
    v_exp_f32 v70, v70
    v_exp_f32 v71, v71
    v_cvt_pk_bf16_f32 v161, v66, v67
    v_exp_f32 v72, v72
    v_mfma_f32_32x32x16_bf16 v[96:111], v[148:151], v[172:175], v[96:111]
    v_exp_f32 v73, v73
    v_cvt_pk_bf16_f32 v162, v68, v69
    v_exp_f32 v74, v74
    v_exp_f32 v75, v75
    v_cvt_pk_bf16_f32 v163, v70, v71
    v_exp_f32 v76, v76
    s_add_u32 m0, s52, 98304
    v_exp_f32 v77, v77
    buffer_load_dwordx4 v1, s[48:51], s19 offen offset:3072 sc1 lds
    v_cvt_pk_bf16_f32 v164, v72, v73
    v_exp_f32 v78, v78
    s_waitcnt lgkmcnt(2)
    v_exp_f32 v79, v79
    v_cvt_pk_bf16_f32 v165, v74, v75
    v_cvt_pk_bf16_f32 v166, v76, v77
    v_cvt_pk_bf16_f32 v167, v78, v79
    v_mfma_f32_32x32x16_bf16 v[64:79], v[128:131], v[8:11], v[48:63]
    v_exp_f32 v80, v80
    v_exp_f32 v81, v81
    ds_read_b128 v[144:147], v179 offset:41600
    v_exp_f32 v82, v82
    ds_read_b128 v[148:151], v180 offset:41600
    v_exp_f32 v83, v83
    v_mfma_f32_32x32x16_bf16 v[112:127], v[152:155], v[160:163], 0
    v_exp_f32 v84, v84
    s_mov_b64 exec, 2
    buffer_store_dword v14, v13, s[48:51], s64 offen sc1
    s_mov_b64 exec, -1
    v_exp_f32 v85, v85
    v_cvt_pk_bf16_f32 v168, v80, v81
    v_exp_f32 v86, v86
    v_exp_f32 v87, v87
    v_cvt_pk_bf16_f32 v169, v82, v83
    v_exp_f32 v88, v88
    v_mfma_f32_32x32x16_bf16 v[112:127], v[156:159], v[164:167], v[112:127]
    v_exp_f32 v89, v89
    v_cvt_pk_bf16_f32 v170, v84, v85
    v_exp_f32 v90, v90
    v_exp_f32 v91, v91
    v_cvt_pk_bf16_f32 v171, v86, v87
    v_exp_f32 v92, v92
    v_exp_f32 v93, v93
    v_cvt_pk_bf16_f32 v172, v88, v89
    v_exp_f32 v94, v94
    v_exp_f32 v95, v95
    v_cvt_pk_bf16_f32 v173, v90, v91
    v_cvt_pk_bf16_f32 v174, v92, v93
    v_cvt_pk_bf16_f32 v175, v94, v95
    v_exp_f32 v64, v64
    v_exp_f32 v65, v65
    v_exp_f32 v66, v66
    v_exp_f32 v67, v67
    s_waitcnt lgkmcnt(2)
    v_mfma_f32_32x32x16_bf16 v[112:127], v[136:139], v[168:171], v[112:127]
    v_exp_f32 v68, v68
    v_exp_f32 v69, v69
    buffer_load_dwordx4 a[0:3], v1, s[48:51], s83 offen sc1
    v_cvt_pk_bf16_f32 v160, v64, v65
    v_exp_f32 v70, v70
    v_exp_f32 v71, v71
    v_cvt_pk_bf16_f32 v161, v66, v67
    v_exp_f32 v72, v72
    v_mfma_f32_32x32x16_bf16 v[112:127], v[140:143], v[172:175], v[112:127]
    s_waitcnt vmcnt(6)
    s_barrier
    ds_read_b128 v[132:135], v176 offset:16640
    ds_read_b128 v[128:131], v176 offset:20800
    ds_read_b128 v[152:155], v177 offset:16640
    ds_read_b128 v[156:159], v178 offset:16640
    v_exp_f32 v73, v73
    v_cvt_pk_bf16_f32 v162, v68, v69
    v_exp_f32 v74, v74
    v_exp_f32 v75, v75
    v_cvt_pk_bf16_f32 v163, v70, v71
    v_exp_f32 v76, v76
    v_exp_f32 v77, v77
    v_cvt_pk_bf16_f32 v164, v72, v73
    v_exp_f32 v78, v78
    v_exp_f32 v79, v79
    v_cvt_pk_bf16_f32 v165, v74, v75
    s_waitcnt lgkmcnt(3)
    v_mfma_f32_32x32x16_bf16 v[80:95], v[132:135], v[4:7], 0
    v_cvt_pk_bf16_f32 v166, v76, v77
    v_cvt_pk_bf16_f32 v167, v78, v79
    s_waitcnt lgkmcnt(2)
    v_mfma_f32_32x32x16_bf16 v[64:79], v[128:131], v[4:7], 0
    s_nop 7
    v_exp_f32 v80, v80
    ds_read_b128 v[132:135], v176 offset:24960
    v_exp_f32 v81, v81
    ds_read_b128 v[136:139], v177 offset:20800
    v_exp_f32 v82, v82
    ds_read_b128 v[140:143], v178 offset:20800
    v_exp_f32 v83, v83
    v_mfma_f32_32x32x16_bf16 v[112:127], v[144:147], v[160:163], v[112:127]
    v_exp_f32 v84, v84
    v_exp_f32 v85, v85
    buffer_load_dwordx4 a[32:35], v1, s[48:51], s90 offen sc1
    v_cvt_pk_bf16_f32 v168, v80, v81
    v_exp_f32 v86, v86
    v_exp_f32 v87, v87
    buffer_load_dwordx4 a[4:7], v1, s[48:51], s83 offen offset:1024 sc1
    v_cvt_pk_bf16_f32 v169, v82, v83
    v_exp_f32 v88, v88
    v_mfma_f32_32x32x16_bf16 v[112:127], v[148:151], v[164:167], v[112:127]
    v_exp_f32 v89, v89
    buffer_load_dwordx4 a[36:39], v1, s[48:51], s90 offen offset:1024 sc1
    v_cvt_pk_bf16_f32 v170, v84, v85
    v_exp_f32 v90, v90
    v_exp_f32 v91, v91
    v_cvt_pk_bf16_f32 v171, v86, v87
    v_exp_f32 v92, v92
    s_add_u32 s89, s22, 1
    s_and_b32 s89, s89, 7
    s_mul_i32 s89, s89, 176128
    s_add_u32 s89, s89, s85
    s_add_u32 m0, s86, 12288
    v_exp_f32 v93, v93
    buffer_load_dwordx4 v232, s[12:15], s89 offen lds
    v_cvt_pk_bf16_f32 v172, v88, v89
    v_exp_f32 v94, v94
    s_waitcnt lgkmcnt(2)
    v_exp_f32 v95, v95
    v_cvt_pk_bf16_f32 v173, v90, v91
    v_cvt_pk_bf16_f32 v174, v92, v93
    v_cvt_pk_bf16_f32 v175, v94, v95
    v_mfma_f32_32x32x16_bf16 v[80:95], v[132:135], v[4:7], 0
    v_exp_f32 v64, v64
    ds_read_b128 v[128:131], v176 offset:29120
    v_exp_f32 v65, v65
    ds_read_b128 v[144:147], v177 offset:24960
    v_exp_f32 v66, v66
    ds_read_b128 v[148:151], v178 offset:24960
    v_exp_f32 v67, v67
    v_mfma_f32_32x32x16_bf16 v[96:111], v[152:155], v[168:171], v[96:111]
    v_exp_f32 v68, v68
    v_exp_f32 v69, v69
    buffer_load_dwordx4 a[8:11], v1, s[48:51], s83 offen offset:2048 sc1
    v_cvt_pk_bf16_f32 v160, v64, v65
    v_exp_f32 v70, v70
    s_add_u32 m0, s86, 13312
    v_exp_f32 v71, v71
    buffer_load_dwordx4 v233, s[12:15], s89 offen lds
    v_cvt_pk_bf16_f32 v161, v66, v67
    v_exp_f32 v72, v72
    v_mfma_f32_32x32x16_bf16 v[96:111], v[156:159], v[172:175], v[96:111]
    v_exp_f32 v73, v73
    buffer_load_dwordx4 a[40:43], v1, s[48:51], s90 offen offset:2048 sc1
    v_cvt_pk_bf16_f32 v162, v68, v69
    v_exp_f32 v74, v74
    v_exp_f32 v75, v75
    v_cvt_pk_bf16_f32 v163, v70, v71
    v_exp_f32 v76, v76
    s_add_u32 m0, s86, 14336
    v_exp_f32 v77, v77
    buffer_load_dwordx4 v234, s[12:15], s89 offen lds
    v_cvt_pk_bf16_f32 v164, v72, v73
    v_exp_f32 v78, v78
    s_waitcnt lgkmcnt(2)
    v_exp_f32 v79, v79
    v_cvt_pk_bf16_f32 v165, v74, v75
    v_cvt_pk_bf16_f32 v166, v76, v77
    v_cvt_pk_bf16_f32 v167, v78, v79
    v_mfma_f32_32x32x16_bf16 v[64:79], v[128:131], v[4:7], 0
    v_exp_f32 v80, v80
    ds_read_b128 v[132:135], v176 offset:17664
    v_exp_f32 v81, v81
    ds_read_b128 v[152:155], v177 offset:29120
    v_exp_f32 v82, v82
    ds_read_b128 v[156:159], v178 offset:29120
    v_exp_f32 v83, v83
    v_mfma_f32_32x32x16_bf16 v[96:111], v[136:139], v[160:163], v[96:111]
    v_exp_f32 v84, v84
    v_exp_f32 v85, v85
    buffer_load_dwordx4 a[12:15], v1, s[48:51], s83 offen offset:3072 sc1
    v_cvt_pk_bf16_f32 v168, v80, v81
    v_exp_f32 v86, v86
    v_exp_f32 v87, v87
    buffer_load_dwordx4 v[212:215], v1, s[48:51], s74 offen sc1
    v_cvt_pk_bf16_f32 v169, v82, v83
    v_exp_f32 v88, v88
    s_add_u32 s89, s22, 2
    s_and_b32 s89, s89, 7
    s_mul_i32 s89, s89, 176128
    s_add_u32 s89, s89, s85
    s_add_u32 m0, s86, 24576
    v_mfma_f32_32x32x16_bf16 v[96:111], v[140:143], v[164:167], v[96:111]
    v_exp_f32 v89, v89
    buffer_load_dwordx4 v232, s[12:15], s89 offen lds
    v_cvt_pk_bf16_f32 v170, v84, v85
    v_exp_f32 v90, v90
    v_exp_f32 v91, v91
    v_cvt_pk_bf16_f32 v171, v86, v87
    v_exp_f32 v92, v92
    v_exp_f32 v93, v93
    buffer_load_dwordx4 a[44:47], v1, s[48:51], s90 offen offset:3072 sc1
    v_cvt_pk_bf16_f32 v172, v88, v89
    v_exp_f32 v94, v94
    s_waitcnt lgkmcnt(2)
    v_exp_f32 v95, v95
    v_cvt_pk_bf16_f32 v173, v90, v91
    v_cvt_pk_bf16_f32 v174, v92, v93
    v_cvt_pk_bf16_f32 v175, v94, v95
    v_mfma_f32_32x32x16_bf16 v[80:95], v[132:135], v[8:11], 0
    v_exp_f32 v64, v64
    ds_read_b128 v[128:131], v176 offset:21824
    v_exp_f32 v65, v65
    ds_read_b128 v[136:139], v179 offset:16640
    v_exp_f32 v66, v66
    ds_read_b128 v[140:143], v180 offset:16640
    v_exp_f32 v67, v67
    v_mfma_f32_32x32x16_bf16 v[96:111], v[144:147], v[168:171], v[96:111]
    v_exp_f32 v68, v68
    s_add_u32 m0, s86, 25600
    v_exp_f32 v69, v69
    buffer_load_dwordx4 v233, s[12:15], s89 offen lds
    v_cvt_pk_bf16_f32 v160, v64, v65
    v_exp_f32 v70, v70
    v_exp_f32 v71, v71
    v_cvt_pk_bf16_f32 v161, v66, v67
    v_exp_f32 v72, v72
    s_add_u32 s83, s83, 4096
    v_mfma_f32_32x32x16_bf16 v[96:111], v[148:151], v[172:175], v[96:111]
    v_exp_f32 v73, v73
    buffer_load_dwordx4 a[16:19], v1, s[48:51], s83 offen sc1
    v_cvt_pk_bf16_f32 v162, v68, v69
    v_exp_f32 v74, v74
    v_exp_f32 v75, v75
    v_cvt_pk_bf16_f32 v163, v70, v71
    v_exp_f32 v76, v76
    s_add_u32 m0, s86, 26624
    v_exp_f32 v77, v77
    buffer_load_dwordx4 v234, s[12:15], s89 offen lds
    v_cvt_pk_bf16_f32 v164, v72, v73
    v_exp_f32 v78, v78
    s_waitcnt lgkmcnt(2)
    v_exp_f32 v79, v79
    v_cvt_pk_bf16_f32 v165, v74, v75
    v_cvt_pk_bf16_f32 v166, v76, v77
    v_cvt_pk_bf16_f32 v167, v78, v79
    v_mfma_f32_32x32x16_bf16 v[64:79], v[128:131], v[8:11], 0
    v_exp_f32 v80, v80
    ds_read_b128 v[132:135], v176 offset:25984
    v_exp_f32 v81, v81
    ds_read_b128 v[144:147], v179 offset:20800
    v_exp_f32 v82, v82
    ds_read_b128 v[148:151], v180 offset:20800
    v_exp_f32 v83, v83
    v_mfma_f32_32x32x16_bf16 v[96:111], v[152:155], v[160:163], v[96:111]
    v_exp_f32 v84, v84
    s_add_u32 s90, s90, 4096
    v_exp_f32 v85, v85
    buffer_load_dwordx4 a[48:51], v1, s[48:51], s90 offen sc1
    v_cvt_pk_bf16_f32 v168, v80, v81
    v_exp_f32 v86, v86
    v_exp_f32 v87, v87
    v_cvt_pk_bf16_f32 v169, v82, v83
    v_exp_f32 v88, v88
    s_add_u32 s89, s22, 3
    s_and_b32 s89, s89, 7
    s_mul_i32 s89, s89, 176128
    s_add_u32 s89, s89, s85
    s_add_u32 m0, s86, 36864
    v_mfma_f32_32x32x16_bf16 v[96:111], v[156:159], v[164:167], v[96:111]
    v_exp_f32 v89, v89
    buffer_load_dwordx4 v232, s[12:15], s89 offen lds
    v_cvt_pk_bf16_f32 v170, v84, v85
    v_exp_f32 v90, v90
    v_exp_f32 v91, v91
    v_cvt_pk_bf16_f32 v171, v86, v87
    v_exp_f32 v92, v92
    v_exp_f32 v93, v93
    buffer_load_dwordx4 a[20:23], v1, s[48:51], s83 offen offset:1024 sc1
    v_cvt_pk_bf16_f32 v172, v88, v89
    v_exp_f32 v94, v94
    s_waitcnt lgkmcnt(2)
    v_exp_f32 v95, v95
    v_cvt_pk_bf16_f32 v173, v90, v91
    v_cvt_pk_bf16_f32 v174, v92, v93
    v_cvt_pk_bf16_f32 v175, v94, v95
    v_mfma_f32_32x32x16_bf16 v[80:95], v[132:135], v[8:11], 0
    v_exp_f32 v64, v64
    ds_read_b128 v[128:131], v176 offset:30144
    v_exp_f32 v65, v65
    ds_read_b128 v[152:155], v179 offset:24960
    v_exp_f32 v66, v66
    ds_read_b128 v[156:159], v180 offset:24960
    v_exp_f32 v67, v67
    v_mfma_f32_32x32x16_bf16 v[112:127], v[136:139], v[168:171], v[112:127]
    v_exp_f32 v68, v68
    s_add_u32 m0, s86, 37888
    v_exp_f32 v69, v69
    buffer_load_dwordx4 v233, s[12:15], s89 offen lds
    v_cvt_pk_bf16_f32 v160, v64, v65
    v_exp_f32 v70, v70
    v_exp_f32 v71, v71
    v_cvt_pk_bf16_f32 v161, v66, v67
    v_exp_f32 v72, v72
    v_mfma_f32_32x32x16_bf16 v[112:127], v[140:143], v[172:175], v[112:127]
    v_exp_f32 v73, v73
    buffer_load_dwordx4 a[52:55], v1, s[48:51], s90 offen offset:1024 sc1
    v_cvt_pk_bf16_f32 v162, v68, v69
    v_exp_f32 v74, v74
    v_exp_f32 v75, v75
    v_cvt_pk_bf16_f32 v163, v70, v71
    v_exp_f32 v76, v76
    s_add_u32 m0, s86, 38912
    v_exp_f32 v77, v77
    buffer_load_dwordx4 v234, s[12:15], s89 offen lds
    v_cvt_pk_bf16_f32 v164, v72, v73
    v_exp_f32 v78, v78
    s_waitcnt lgkmcnt(2)
    v_exp_f32 v79, v79
    v_cvt_pk_bf16_f32 v165, v74, v75
    v_cvt_pk_bf16_f32 v166, v76, v77
    v_cvt_pk_bf16_f32 v167, v78, v79
    v_mfma_f32_32x32x16_bf16 v[64:79], v[128:131], v[8:11], 0
    v_exp_f32 v80, v80
    v_exp_f32 v81, v81
    ds_read_b128 v[136:139], v179 offset:29120
    v_exp_f32 v82, v82
    ds_read_b128 v[140:143], v180 offset:29120
    v_exp_f32 v83, v83
    v_mfma_f32_32x32x16_bf16 v[112:127], v[144:147], v[160:163], v[112:127]
    v_exp_f32 v84, v84
    v_exp_f32 v85, v85
    buffer_load_dwordx4 a[24:27], v1, s[48:51], s83 offen offset:2048 sc1
    v_cvt_pk_bf16_f32 v168, v80, v81
    v_exp_f32 v86, v86
    v_exp_f32 v87, v87
    v_cvt_pk_bf16_f32 v169, v82, v83
    v_exp_f32 v88, v88
    s_waitcnt vmcnt(12)
    v_xor_b32 v231, s59, v212
    v_bitop3_b32 v231, v231, v213, s59 bitop3:0xf6
    v_bitop3_b32 v231, v231, v214, s59 bitop3:0xf6
    v_bitop3_b32 v231, v231, v215, s59 bitop3:0xf6
    v_cmp_ne_u32 vcc, 0, v231
    s_cbranch_vccz L_seen_17
L_poll_18:
    buffer_load_dwordx4 v[212:215], v1, s[48:51], s74 offen sc1
    s_waitcnt vmcnt(0)
    v_xor_b32 v231, s59, v212
    v_bitop3_b32 v231, v231, v213, s59 bitop3:0xf6
    v_bitop3_b32 v231, v231, v214, s59 bitop3:0xf6
    v_bitop3_b32 v231, v231, v215, s59 bitop3:0xf6
    v_cmp_ne_u32 vcc, 0, v231
    s_cbranch_vccz L_polled_19
    s_cmp_eq_u32 s61, 0
    s_cbranch_scc1 L_polled_19
    s_sub_u32 s61, s61, 1
    s_sleep 4
    s_branch L_poll_18
L_polled_19:
L_seen_17:
    v_mfma_f32_32x32x16_bf16 v[112:127], v[148:151], v[164:167], v[112:127]
    v_exp_f32 v89, v89
    v_cvt_pk_bf16_f32 v170, v84, v85
    v_exp_f32 v90, v90
    v_exp_f32 v91, v91
    v_cvt_pk_bf16_f32 v171, v86, v87
    v_exp_f32 v92, v92
    s_mov_b32 s3, 65536
    v_exp_f32 v93, v93
    buffer_load_dwordx4 v[212:215], v230, s[48:51], s3 offen sc1
    v_cvt_pk_bf16_f32 v172, v88, v89
    v_exp_f32 v94, v94
    v_exp_f32 v95, v95
    v_cvt_pk_bf16_f32 v173, v90, v91
    v_cvt_pk_bf16_f32 v174, v92, v93
    v_cvt_pk_bf16_f32 v175, v94, v95
    v_exp_f32 v64, v64
    v_exp_f32 v65, v65
    v_exp_f32 v66, v66
    v_exp_f32 v67, v67
    s_waitcnt lgkmcnt(2)
    v_mfma_f32_32x32x16_bf16 v[112:127], v[152:155], v[168:171], v[112:127]
    v_exp_f32 v68, v68
    s_mov_b32 s3, 73728
    v_exp_f32 v69, v69
    buffer_load_dwordx4 v[216:219], v230, s[48:51], s3 offen sc1
    v_cvt_pk_bf16_f32 v160, v64, v65
    v_exp_f32 v70, v70
    v_exp_f32 v71, v71
    v_cvt_pk_bf16_f32 v161, v66, v67
    v_exp_f32 v72, v72
    s_mov_b32 s3, 81920
    v_mfma_f32_32x32x16_bf16 v[112:127], v[156:159], v[172:175], v[112:127]
    buffer_load_dwordx4 v[220:223], v230, s[48:51], s3 offen sc1
    s_barrier
    ds_read_b128 v[132:135], v176 offset:4160
    ds_read_b128 v[128:131], v176 offset:8320
    ds_read_b128 v[144:147], v177 offset:4160
    ds_read_b128 v[148:151], v178 offset:4160
    v_exp_f32 v73, v73
    v_cvt_pk_bf16_f32 v162, v68, v69
    v_exp_f32 v74, v74
    v_exp_f32 v75, v75
    v_cvt_pk_bf16_f32 v163, v70, v71
    v_exp_f32 v76, v76
    s_mov_b32 s3, 90112
    v_exp_f32 v77, v77
    buffer_load_dwordx4 v[224:227], v230, s[48:51], s3 offen sc1
    v_cvt_pk_bf16_f32 v164, v72, v73
    v_exp_f32 v78, v78
    v_exp_f32 v79, v79
    v_cvt_pk_bf16_f32 v165, v74, v75
    s_waitcnt lgkmcnt(3)
    v_mfma_f32_32x32x16_bf16 v[80:95], v[132:135], v[4:7], v[16:31]
    v_cvt_pk_bf16_f32 v166, v76, v77
    v_cvt_pk_bf16_f32 v167, v78, v79
    s_waitcnt lgkmcnt(2)
    v_mfma_f32_32x32x16_bf16 v[64:79], v[128:131], v[4:7], 0
    s_nop 7
    v_exp_f32 v80, v80
    ds_read_b128 v[132:135], v176 offset:12480
    v_exp_f32 v81, v81
    ds_read_b128 v[152:155], v177 offset:8320
    v_exp_f32 v82, v82
    ds_read_b128 v[156:159], v178 offset:8320
    v_exp_f32 v83, v83
    v_mfma_f32_32x32x16_bf16 v[112:127], v[136:139], v[160:163], v[112:127]
    v_exp_f32 v84, v84
    s_add_u32 s89, s22, 4
    s_and_b32 s89, s89, 7
    s_mul_i32 s89, s89, 176128
    s_add_u32 s89, s89, s85
    s_add_u32 m0, s86, 49152
    v_exp_f32 v85, v85
    buffer_load_dwordx4 v232, s[12:15], s89 offen lds
    v_cvt_pk_bf16_f32 v168, v80, v81
    v_exp_f32 v86, v86
    v_exp_f32 v87, v87
    v_cvt_pk_bf16_f32 v169, v82, v83
    v_exp_f32 v88, v88
    v_mfma_f32_32x32x16_bf16 v[112:127], v[140:143], v[164:167], v[112:127]
    v_exp_f32 v89, v89
    buffer_load_dwordx4 a[56:59], v1, s[48:51], s90 offen offset:2048 sc1
    v_cvt_pk_bf16_f32 v170, v84, v85
    v_exp_f32 v90, v90
    v_exp_f32 v91, v91
    v_cvt_pk_bf16_f32 v171, v86, v87
    v_exp_f32 v92, v92
    s_add_u32 m0, s86, 50176
    v_exp_f32 v93, v93
    buffer_load_dwordx4 v233, s[12:15], s89 offen lds
    v_cvt_pk_bf16_f32 v172, v88, v89
    v_exp_f32 v94, v94
    s_waitcnt lgkmcnt(2)
    v_exp_f32 v95, v95
    v_cvt_pk_bf16_f32 v173, v90, v91
    v_cvt_pk_bf16_f32 v174, v92, v93
    v_cvt_pk_bf16_f32 v175, v94, v95
    v_mfma_f32_32x32x16_bf16 v[80:95], v[132:135], v[4:7], 0
    v_exp_f32 v64, v64
    ds_read_b128 v[128:131], v176 offset:9344
    v_exp_f32 v65, v65
    ds_read_b128 v[136:139], v177 offset:12480
    v_exp_f32 v66, v66
    ds_read_b128 v[140:143], v178 offset:12480
    v_exp_f32 v67, v67
    v_mfma_f32_32x32x16_bf16 v[96:111], v[144:147], v[168:171], v[96:111]
    v_exp_f32 v68, v68
    v_exp_f32 v69, v69
    buffer_load_dwordx4 a[28:31], v1, s[48:51], s83 offen offset:3072 sc1
    v_cvt_pk_bf16_f32 v160, v64, v65
    v_exp_f32 v70, v70
    v_exp_f32 v71, v71
    v_cvt_pk_bf16_f32 v161, v66, v67
    v_exp_f32 v72, v72
    s_add_u32 m0, s86, 51200
    v_mfma_f32_32x32x16_bf16 v[96:111], v[148:151], v[172:175], v[96:111]
    v_exp_f32 v73, v73
    buffer_load_dwordx4 v234, s[12:15], s89 offen lds
    v_cvt_pk_bf16_f32 v162, v68, v69
    v_exp_f32 v74, v74
    v_exp_f32 v75, v75
    v_cvt_pk_bf16_f32 v163, v70, v71
    v_exp_f32 v76, v76
    v_exp_f32 v77, v77
    buffer_load_dwordx4 a[60:63], v1, s[48:51], s90 offen offset:3072 sc1
    v_cvt_pk_bf16_f32 v164, v72, v73
    v_exp_f32 v78, v78
    s_waitcnt lgkmcnt(2)
    v_exp_f32 v79, v79
    v_cvt_pk_bf16_f32 v165, v74, v75
    v_cvt_pk_bf16_f32 v166, v76, v77
    v_cvt_pk_bf16_f32 v167, v78, v79
    v_mfma_f32_32x32x16_bf16 v[64:79], v[128:131], v[8:11], v[16:31]
    v_exp_f32 v80, v80
    ds_read_b128 v[132:135], v176 offset:13504
    v_exp_f32 v81, v81
    ds_read_b128 v[144:147], v179 offset:8320
    v_exp_f32 v82, v82
    ds_read_b128 v[148:151], v180 offset:8320
    v_exp_f32 v83, v83
    v_mfma_f32_32x32x16_bf16 v[96:111], v[152:155], v[160:163], v[96:111]
    v_exp_f32 v84, v84
    s_add_u32 s89, s22, 5
    s_and_b32 s89, s89, 7
    s_mul_i32 s89, s89, 176128
    s_add_u32 s89, s89, s85
    s_add_u32 m0, s86, 61440
    v_exp_f32 v85, v85
    buffer_load_dwordx4 v232, s[12:15], s89 offen lds
    v_cvt_pk_bf16_f32 v168, v80, v81
    v_exp_f32 v86, v86
    v_exp_f32 v87, v87
    v_cvt_pk_bf16_f32 v169, v82, v83
    v_exp_f32 v88, v88
    s_add_u32 m0, s86, 62464
    v_mfma_f32_32x32x16_bf16 v[96:111], v[156:159], v[164:167], v[96:111]
    v_exp_f32 v89, v89
    buffer_load_dwordx4 v233, s[12:15], s89 offen lds
    v_cvt_pk_bf16_f32 v170, v84, v85
    v_exp_f32 v90, v90
    v_exp_f32 v91, v91
    v_cvt_pk_bf16_f32 v171, v86, v87
    v_exp_f32 v92, v92
    s_add_u32 m0, s86, 63488
    v_exp_f32 v93, v93
    buffer_load_dwordx4 v234, s[12:15], s89 offen lds
    v_cvt_pk_bf16_f32 v172, v88, v89
    v_exp_f32 v94, v94
    s_waitcnt lgkmcnt(2)
    v_exp_f32 v95, v95
    v_cvt_pk_bf16_f32 v173, v90, v91
    v_cvt_pk_bf16_f32 v174, v92, v93
    v_cvt_pk_bf16_f32 v175, v94, v95
    v_mfma_f32_32x32x16_bf16 v[80:95], v[132:135], v[8:11], 0
    v_exp_f32 v64, v64
    v_exp_f32 v65, v65
    ds_read_b128 v[152:155], v179 offset:12480
    v_exp_f32 v66, v66
    ds_read_b128 v[156:159], v180 offset:12480
    v_exp_f32 v67, v67
    v_mfma_f32_32x32x16_bf16 v[96:111], v[136:139], v[168:171], v[96:111]
    v_exp_f32 v68, v68
    v_exp_f32 v69, v69
    buffer_load_dwordx4 a[64:67], v1, s[48:51], s84 offen sc1
    v_cvt_pk_bf16_f32 v160, v64, v65
    v_exp_f32 v70, v70
    v_exp_f32 v71, v71
    v_cvt_pk_bf16_f32 v161, v66, v67
    v_exp_f32 v72, v72
    v_mfma_f32_32x32x16_bf16 v[96:111], v[140:143], v[172:175], v[96:111]
    v_exp_f32 v73, v73
    buffer_load_dwordx4 a[152:155], v1, s[48:51], s91 offen sc1
    v_cvt_pk_bf16_f32 v162, v68, v69
    v_exp_f32 v74, v74
    v_exp_f32 v75, v75
    v_cvt_pk_bf16_f32 v163, v70, v71
    v_exp_f32 v76, v76
    v_exp_f32 v77, v77
    buffer_load_dwordx4 a[68:71], v1, s[48:51], s84 offen offset:1024 sc1
    v_cvt_pk_bf16_f32 v164, v72, v73
    v_exp_f32 v78, v78
    v_exp_f32 v79, v79
    v_cvt_pk_bf16_f32 v165, v74, v75
    v_cvt_pk_bf16_f32 v166, v76, v77
    v_cvt_pk_bf16_f32 v167, v78, v79
    v_exp_f32 v80, v80
    v_exp_f32 v81, v81
    v_exp_f32 v82, v82
    v_exp_f32 v83, v83
    s_waitcnt lgkmcnt(2)
    v_mfma_f32_32x32x16_bf16 v[112:127], v[144:147], v[160:163], v[112:127]
    v_exp_f32 v84, v84
    v_exp_f32 v85, v85
    v_cvt_pk_bf16_f32 v168, v80, v81
    v_exp_f32 v86, v86
    v_exp_f32 v87, v87
    v_cvt_pk_bf16_f32 v169, v82, v83
    v_exp_f32 v88, v88
    v_mfma_f32_32x32x16_bf16 v[112:127], v[148:151], v[164:167], v[112:127]
    v_exp_f32 v89, v89
    v_cvt_pk_bf16_f32 v170, v84, v85
    v_exp_f32 v90, v90
    v_exp_f32 v91, v91
    v_cvt_pk_bf16_f32 v171, v86, v87
    v_exp_f32 v92, v92
    v_exp_f32 v93, v93
    v_cvt_pk_bf16_f32 v172, v88, v89
    v_exp_f32 v94, v94
    v_exp_f32 v95, v95
    v_cvt_pk_bf16_f32 v173, v90, v91
    v_cvt_pk_bf16_f32 v174, v92, v93
    v_cvt_pk_bf16_f32 v175, v94, v95
    s_waitcnt lgkmcnt(0)
    v_mfma_f32_32x32x16_bf16 v[112:127], v[152:155], v[168:171], v[112:127]
    v_mfma_f32_32x32x16_bf16 v[112:127], v[156:159], v[172:175], v[112:127]
    s_branch L_att_done
L_att2:
    ds_read_b128 v[128:131], v176 offset:33280
    ds_read_b128 v[132:135], v176 offset:37440
    ds_read_b128 v[136:139], v177 offset:33280
    ds_read_b128 v[140:143], v178 offset:33280
    s_waitcnt lgkmcnt(4)
    s_waitcnt lgkmcnt(3)
    v_mfma_f32_32x32x16_bf16 v[64:79], v[128:131], v[4:7], 0
    s_waitcnt lgkmcnt(2)
    v_mfma_f32_32x32x16_bf16 v[80:95], v[132:135], v[4:7], 0
    s_add_u32 s89, s22, 0
    s_and_b32 s89, s89, 7
    s_mul_i32 s89, s89, 176128
    s_add_u32 s89, s89, s85
    s_add_u32 m0, s86, 0
    s_nop 0
    buffer_load_dwordx4 v232, s[12:15], s89 offen lds
    s_add_u32 m0, s86, 1024
    s_nop 0
    buffer_load_dwordx4 v233, s[12:15], s89 offen lds
    s_add_u32 m0, s86, 2048
    s_nop 0
    buffer_load_dwordx4 v234, s[12:15], s89 offen lds
L_poll_20:
    buffer_load_dword v15, v222, s[48:51], s69 offen sc1
    buffer_load_dwordx4 v[212:215], v1, s[48:51], s25 offen sc1
    s_waitcnt vmcnt(0)
    v_xor_b32 v15, s59, v15
    v_bitop3_b32 v15, v15, v212, s59 bitop3:0xf6
    v_bitop3_b32 v15, v15, v213, s59 bitop3:0xf6
    v_bitop3_b32 v15, v15, v214, s59 bitop3:0xf6
    v_bitop3_b32 v15, v15, v215, s59 bitop3:0xf6
    v_cmp_ne_u32 vcc, 0, v15
    s_cbranch_vccz L_polled_21
    s_cmp_eq_u32 s61, 0
    s_cbranch_scc1 L_polled_21
    s_sub_u32 s61, s61, 1
    s_sleep 1
    s_branch L_poll_20
L_polled_21:
    s_add_u32 m0, s52, 114944
    s_nop 0
    buffer_load_dwordx4 v1, s[48:51], s18 offen sc1 lds
    s_add_u32 m0, s52, 114944
    s_nop 0
    buffer_load_dwordx4 v1, s[48:51], s18 offen offset:1024 sc1 lds
    v_exp_f32 v64, v64
    ds_read_b128 v[128:131], v176 offset:41600
    v_exp_f32 v65, v65
    ds_read_b128 v[144:147], v177 offset:37440
    v_exp_f32 v66, v66
    ds_read_b128 v[148:151], v178 offset:37440
    v_exp_f32 v67, v67
    v_exp_f32 v68, v68
    s_add_u32 m0, s52, 114944
    v_exp_f32 v69, v69
    buffer_load_dwordx4 v1, s[48:51], s18 offen offset:2048 sc1 lds
    v_cvt_pk_bf16_f32 v160, v64, v65
    v_exp_f32 v70, v70
    v_exp_f32 v71, v71
    v_cvt_pk_bf16_f32 v161, v66, v67
    v_exp_f32 v72, v72
    v_exp_f32 v73, v73
    v_cvt_pk_bf16_f32 v162, v68, v69
    v_exp_f32 v74, v74
    v_exp_f32 v75, v75
    v_cvt_pk_bf16_f32 v163, v70, v71
    v_exp_f32 v76, v76
    s_add_u32 m0, s52, 114944
    v_exp_f32 v77, v77
    buffer_load_dwordx4 v1, s[48:51], s18 offen offset:3072 sc1 lds
    v_cvt_pk_bf16_f32 v164, v72, v73
    v_exp_f32 v78, v78
    s_waitcnt lgkmcnt(2)
    v_exp_f32 v79, v79
    v_cvt_pk_bf16_f32 v165, v74, v75
    v_cvt_pk_bf16_f32 v166, v76, v77
    v_cvt_pk_bf16_f32 v167, v78, v79
    v_mfma_f32_32x32x16_bf16 v[64:79], v[128:131], v[4:7], v[48:63]
    v_exp_f32 v80, v80
    ds_read_b128 v[132:135], v176 offset:34304
    v_exp_f32 v81, v81
    ds_read_b128 v[152:155], v177 offset:41600
    v_exp_f32 v82, v82
    ds_read_b128 v[156:159], v178 offset:41600
    v_exp_f32 v83, v83
    v_mfma_f32_32x32x16_bf16 v[96:111], v[136:139], v[160:163], 0
    v_exp_f32 v84, v84
    s_add_u32 m0, s52, 98304
    v_exp_f32 v85, v85
    buffer_load_dwordx4 v1, s[48:51], s19 offen sc1 lds
    v_cvt_pk_bf16_f32 v168, v80, v81
    v_exp_f32 v86, v86
    v_exp_f32 v87, v87
    v_cvt_pk_bf16_f32 v169, v82, v83
    v_exp_f32 v88, v88
    v_mfma_f32_32x32x16_bf16 v[96:111], v[140:143], v[164:167], v[96:111]
    v_exp_f32 v89, v89
    v_cvt_pk_bf16_f32 v170, v84, v85
    v_exp_f32 v90, v90
    v_exp_f32 v91, v91
    v_cvt_pk_bf16_f32 v171, v86, v87
    v_exp_f32 v92, v92
    s_add_u32 m0, s52, 98304
    v_exp_f32 v93, v93
    buffer_load_dwordx4 v1, s[48:51], s19 offen offset:1024 sc1 lds
    v_cvt_pk_bf16_f32 v172, v88, v89
    v_exp_f32 v94, v94
    s_waitcnt lgkmcnt(2)
    v_exp_f32 v95, v95
    v_cvt_pk_bf16_f32 v173, v90, v91
    v_cvt_pk_bf16_f32 v174, v92, v93
    v_cvt_pk_bf16_f32 v175, v94, v95
    v_mfma_f32_32x32x16_bf16 v[80:95], v[132:135], v[8:11], 0
    v_exp_f32 v64, v64
    ds_read_b128 v[128:131], v176 offset:38464
    v_exp_f32 v65, v65
    ds_read_b128 v[136:139], v179 offset:33280
    v_exp_f32 v66, v66
    ds_read_b128 v[140:143], v180 offset:33280
    v_exp_f32 v67, v67
    v_mfma_f32_32x32x16_bf16 v[96:111], v[144:147], v[168:171], v[96:111]
    v_exp_f32 v68, v68
    s_add_u32 m0, s52, 98304
    v_exp_f32 v69, v69
    buffer_load_dwordx4 v1, s[48:51], s19 offen offset:2048 sc1 lds
    v_cvt_pk_bf16_f32 v160, v64, v65
    v_exp_f32 v70, v70
    v_exp_f32 v71, v71
    v_cvt_pk_bf16_f32 v161, v66, v67
    v_exp_f32 v72, v72
    v_mfma_f32_32x32x16_bf16 v[96:111], v[148:151], v[172:175], v[96:111]
    v_exp_f32 v73, v73
    v_cvt_pk_bf16_f32 v162, v68, v69
    v_exp_f32 v74, v74
    v_exp_f32 v75, v75
    v_cvt_pk_bf16_f32 v163, v70, v71
    v_exp_f32 v76, v76
    s_add_u32 m0, s52, 98304
    v_exp_f32 v77, v77
    buffer_load_dwordx4 v1, s[48:51], s19 offen offset:3072 sc1 lds
    v_cvt_pk_bf16_f32 v164, v72, v73
    v_exp_f32 v78, v78
    s_waitcnt lgkmcnt(2)
    v_exp_f32 v79, v79
    v_cvt_pk_bf16_f32 v165, v74, v75
    v_cvt_pk_bf16_f32 v166, v76, v77
    v_cvt_pk_bf16_f32 v167, v78, v79
    v_mfma_f32_32x32x16_bf16 v[64:79], v[128:131], v[8:11], v[48:63]
    v_exp_f32 v80, v80
    v_exp_f32 v81, v81
    ds_read_b128 v[144:147], v179 offset:37440
    v_exp_f32 v82, v82
    ds_read_b128 v[148:151], v180 offset:37440
    v_exp_f32 v83, v83
    v_mfma_f32_32x32x16_bf16 v[96:111], v[152:155], v[160:163], v[96:111]
    v_exp_f32 v84, v84
    s_mov_b64 exec, 2
    buffer_store_dword v14, v13, s[48:51], s64 offen sc1
    s_mov_b64 exec, -1
    v_exp_f32 v85, v85
    v_cvt_pk_bf16_f32 v168, v80, v81
    v_exp_f32 v86, v86
    v_exp_f32 v87, v87
    v_cvt_pk_bf16_f32 v169, v82, v83
    v_exp_f32 v88, v88
    v_mfma_f32_32x32x16_bf16 v[96:111], v[156:159], v[164:167], v[96:111]
    v_exp_f32 v89, v89
    v_cvt_pk_bf16_f32 v170, v84, v85
    v_exp_f32 v90, v90
    v_exp_f32 v91, v91
    v_cvt_pk_bf16_f32 v171, v86, v87
    v_exp_f32 v92, v92
    v_exp_f32 v93, v93
    v_cvt_pk_bf16_f32 v172, v88, v89
    v_exp_f32 v94, v94
    v_exp_f32 v95, v95
    v_cvt_pk_bf16_f32 v173, v90, v91
    v_cvt_pk_bf16_f32 v174, v92, v93
    v_cvt_pk_bf16_f32 v175, v94, v95
    v_exp_f32 v64, v64
    v_exp_f32 v65, v65
    v_exp_f32 v66, v66
    v_exp_f32 v67, v67
    s_waitcnt lgkmcnt(2)
    v_mfma_f32_32x32x16_bf16 v[112:127], v[136:139], v[168:171], 0
    v_exp_f32 v68, v68
    v_exp_f32 v69, v69
    buffer_load_dwordx4 a[0:3], v1, s[48:51], s83 offen sc1
    v_cvt_pk_bf16_f32 v160, v64, v65
    v_exp_f32 v70, v70
    v_exp_f32 v71, v71
    v_cvt_pk_bf16_f32 v161, v66, v67
    v_exp_f32 v72, v72
    v_mfma_f32_32x32x16_bf16 v[112:127], v[140:143], v[172:175], v[112:127]
    s_waitcnt vmcnt(6)
    s_barrier
    ds_read_b128 v[132:135], v176 offset:16640
    ds_read_b128 v[128:131], v176 offset:20800
    ds_read_b128 v[152:155], v177 offset:16640
    ds_read_b128 v[156:159], v178 offset:16640
    v_exp_f32 v73, v73
    v_cvt_pk_bf16_f32 v162, v68, v69
    v_exp_f32 v74, v74
    v_exp_f32 v75, v75
    v_cvt_pk_bf16_f32 v163, v70, v71
    v_exp_f32 v76, v76
    v_exp_f32 v77, v77
    v_cvt_pk_bf16_f32 v164, v72, v73
    v_exp_f32 v78, v78
    v_exp_f32 v79, v79
    v_cvt_pk_bf16_f32 v165, v74, v75
    s_waitcnt lgkmcnt(3)
    v_mfma_f32_32x32x16_bf16 v[80:95], v[132:135], v[4:7], 0
    v_cvt_pk_bf16_f32 v166, v76, v77
    v_cvt_pk_bf16_f32 v167, v78, v79
    s_waitcnt lgkmcnt(2)
    v_mfma_f32_32x32x16_bf16 v[64:79], v[128:131], v[4:7], 0
    s_nop 7
    v_exp_f32 v80, v80
    ds_read_b128 v[132:135], v176 offset:24960
    v_exp_f32 v81, v81
    ds_read_b128 v[136:139], v177 offset:20800
    v_exp_f32 v82, v82
    ds_read_b128 v[140:143], v178 offset:20800
    v_exp_f32 v83, v83
    v_mfma_f32_32x32x16_bf16 v[112:127], v[144:147], v[160:163], v[112:127]
    v_exp_f32 v84, v84
    v_exp_f32 v85, v85
    buffer_load_dwordx4 a[32:35], v1, s[48:51], s90 offen sc1
    v_cvt_pk_bf16_f32 v168, v80, v81
    v_exp_f32 v86, v86
    v_exp_f32 v87, v87
    buffer_load_dwordx4 a[4:7], v1, s[48:51], s83 offen offset:1024 sc1
    v_cvt_pk_bf16_f32 v169, v82, v83
    v_exp_f32 v88, v88
    v_mfma_f32_32x32x16_bf16 v[112:127], v[148:151], v[164:167], v[112:127]
    v_exp_f32 v89, v89
    buffer_load_dwordx4 a[36:39], v1, s[48:51], s90 offen offset:1024 sc1
    v_cvt_pk_bf16_f32 v170, v84, v85
    v_exp_f32 v90, v90
    v_exp_f32 v91, v91
    v_cvt_pk_bf16_f32 v171, v86, v87
    v_exp_f32 v92, v92
    s_add_u32 s89, s22, 1
    s_and_b32 s89, s89, 7
    s_mul_i32 s89, s89, 176128
    s_add_u32 s89, s89, s85
    s_add_u32 m0, s86, 12288
    v_exp_f32 v93, v93
    buffer_load_dwordx4 v232, s[12:15], s89 offen lds
    v_cvt_pk_bf16_f32 v172, v88, v89
    v_exp_f32 v94, v94
    s_waitcnt lgkmcnt(2)
    v_exp_f32 v95, v95
    v_cvt_pk_bf16_f32 v173, v90, v91
    v_cvt_pk_bf16_f32 v174, v92, v93
    v_cvt_pk_bf16_f32 v175, v94, v95
    v_mfma_f32_32x32x16_bf16 v[80:95], v[132:135], v[4:7], 0
    v_exp_f32 v64, v64
    ds_read_b128 v[128:131], v176 offset:29120
    v_exp_f32 v65, v65
    ds_read_b128 v[144:147], v177 offset:24960
    v_exp_f32 v66, v66
    ds_read_b128 v[148:151], v178 offset:24960
    v_exp_f32 v67, v67
    v_mfma_f32_32x32x16_bf16 v[96:111], v[152:155], v[168:171], v[96:111]
    v_exp_f32 v68, v68
    v_exp_f32 v69, v69
    buffer_load_dwordx4 a[8:11], v1, s[48:51], s83 offen offset:2048 sc1
    v_cvt_pk_bf16_f32 v160, v64, v65
    v_exp_f32 v70, v70
    s_add_u32 m0, s86, 13312
    v_exp_f32 v71, v71
    buffer_load_dwordx4 v233, s[12:15], s89 offen lds
    v_cvt_pk_bf16_f32 v161, v66, v67
    v_exp_f32 v72, v72
    v_mfma_f32_32x32x16_bf16 v[96:111], v[156:159], v[172:175], v[96:111]
    v_exp_f32 v73, v73
    buffer_load_dwordx4 a[40:43], v1, s[48:51], s90 offen offset:2048 sc1
    v_cvt_pk_bf16_f32 v162, v68, v69
    v_exp_f32 v74, v74
    v_exp_f32 v75, v75
    v_cvt_pk_bf16_f32 v163, v70, v71
    v_exp_f32 v76, v76
    s_add_u32 m0, s86, 14336
    v_exp_f32 v77, v77
    buffer_load_dwordx4 v234, s[12:15], s89 offen lds
    v_cvt_pk_bf16_f32 v164, v72, v73
    v_exp_f32 v78, v78
    s_waitcnt lgkmcnt(2)
    v_exp_f32 v79, v79
    v_cvt_pk_bf16_f32 v165, v74, v75
    v_cvt_pk_bf16_f32 v166, v76, v77
    v_cvt_pk_bf16_f32 v167, v78, v79
    v_mfma_f32_32x32x16_bf16 v[64:79], v[128:131], v[4:7], 0
    v_exp_f32 v80, v80
    ds_read_b128 v[132:135], v176 offset:17664
    v_exp_f32 v81, v81
    ds_read_b128 v[152:155], v177 offset:29120
    v_exp_f32 v82, v82
    ds_read_b128 v[156:159], v178 offset:29120
    v_exp_f32 v83, v83
    v_mfma_f32_32x32x16_bf16 v[96:111], v[136:139], v[160:163], v[96:111]
    v_exp_f32 v84, v84
    v_exp_f32 v85, v85
    buffer_load_dwordx4 a[12:15], v1, s[48:51], s83 offen offset:3072 sc1
    v_cvt_pk_bf16_f32 v168, v80, v81
    v_exp_f32 v86, v86
    v_exp_f32 v87, v87
    buffer_load_dwordx4 v[212:215], v1, s[48:51], s74 offen sc1
    v_cvt_pk_bf16_f32 v169, v82, v83
    v_exp_f32 v88, v88
    s_add_u32 s89, s22, 2
    s_and_b32 s89, s89, 7
    s_mul_i32 s89, s89, 176128
    s_add_u32 s89, s89, s85
    s_add_u32 m0, s86, 24576
    v_mfma_f32_32x32x16_bf16 v[96:111], v[140:143], v[164:167], v[96:111]
    v_exp_f32 v89, v89
    buffer_load_dwordx4 v232, s[12:15], s89 offen lds
    v_cvt_pk_bf16_f32 v170, v84, v85
    v_exp_f32 v90, v90
    v_exp_f32 v91, v91
    v_cvt_pk_bf16_f32 v171, v86, v87
    v_exp_f32 v92, v92
    v_exp_f32 v93, v93
    buffer_load_dwordx4 a[44:47], v1, s[48:51], s90 offen offset:3072 sc1
    v_cvt_pk_bf16_f32 v172, v88, v89
    v_exp_f32 v94, v94
    s_waitcnt lgkmcnt(2)
    v_exp_f32 v95, v95
    v_cvt_pk_bf16_f32 v173, v90, v91
    v_cvt_pk_bf16_f32 v174, v92, v93
    v_cvt_pk_bf16_f32 v175, v94, v95
    v_mfma_f32_32x32x16_bf16 v[80:95], v[132:135], v[8:11], 0
    v_exp_f32 v64, v64
    ds_read_b128 v[128:131], v176 offset:21824
    v_exp_f32 v65, v65
    ds_read_b128 v[136:139], v179 offset:16640
    v_exp_f32 v66, v66
    ds_read_b128 v[140:143], v180 offset:16640
    v_exp_f32 v67, v67
    v_mfma_f32_32x32x16_bf16 v[96:111], v[144:147], v[168:171], v[96:111]
    v_exp_f32 v68, v68
    s_add_u32 m0, s86, 25600
    v_exp_f32 v69, v69
    buffer_load_dwordx4 v233, s[12:15], s89 offen lds
    v_cvt_pk_bf16_f32 v160, v64, v65
    v_exp_f32 v70, v70
    v_exp_f32 v71, v71
    v_cvt_pk_bf16_f32 v161, v66, v67
    v_exp_f32 v72, v72
    s_add_u32 s83, s83, 4096
    v_mfma_f32_32x32x16_bf16 v[96:111], v[148:151], v[172:175], v[96:111]
    v_exp_f32 v73, v73
    buffer_load_dwordx4 a[16:19], v1, s[48:51], s83 offen sc1
    v_cvt_pk_bf16_f32 v162, v68, v69
    v_exp_f32 v74, v74
    v_exp_f32 v75, v75
    v_cvt_pk_bf16_f32 v163, v70, v71
    v_exp_f32 v76, v76
    s_add_u32 m0, s86, 26624
    v_exp_f32 v77, v77
    buffer_load_dwordx4 v234, s[12:15], s89 offen lds
    v_cvt_pk_bf16_f32 v164, v72, v73
    v_exp_f32 v78, v78
    s_waitcnt lgkmcnt(2)
    v_exp_f32 v79, v79
    v_cvt_pk_bf16_f32 v165, v74, v75
    v_cvt_pk_bf16_f32 v166, v76, v77
    v_cvt_pk_bf16_f32 v167, v78, v79
    v_mfma_f32_32x32x16_bf16 v[64:79], v[128:131], v[8:11], 0
    v_exp_f32 v80, v80
    ds_read_b128 v[132:135], v176 offset:25984
    v_exp_f32 v81, v81
    ds_read_b128 v[144:147], v179 offset:20800
    v_exp_f32 v82, v82
    ds_read_b128 v[148:151], v180 offset:20800
    v_exp_f32 v83, v83
    v_mfma_f32_32x32x16_bf16 v[96:111], v[152:155], v[160:163], v[96:111]
    v_exp_f32 v84, v84
    s_add_u32 s90, s90, 4096
    v_exp_f32 v85, v85
    buffer_load_dwordx4 a[48:51], v1, s[48:51], s90 offen sc1
    v_cvt_pk_bf16_f32 v168, v80, v81
    v_exp_f32 v86, v86
    v_exp_f32 v87, v87
    v_cvt_pk_bf16_f32 v169, v82, v83
    v_exp_f32 v88, v88
    s_add_u32 s89, s22, 3
    s_and_b32 s89, s89, 7
    s_mul_i32 s89, s89, 176128
    s_add_u32 s89, s89, s85
    s_add_u32 m0, s86, 36864
    v_mfma_f32_32x32x16_bf16 v[96:111], v[156:159], v[164:167], v[96:111]
    v_exp_f32 v89, v89
    buffer_load_dwordx4 v232, s[12:15], s89 offen lds
    v_cvt_pk_bf16_f32 v170, v84, v85
    v_exp_f32 v90, v90
    v_exp_f32 v91, v91
    v_cvt_pk_bf16_f32 v171, v86, v87
    v_exp_f32 v92, v92
    v_exp_f32 v93, v93
    buffer_load_dwordx4 a[20:23], v1, s[48:51], s83 offen offset:1024 sc1
    v_cvt_pk_bf16_f32 v172, v88, v89
    v_exp_f32 v94, v94
    s_waitcnt lgkmcnt(2)
    v_exp_f32 v95, v95
    v_cvt_pk_bf16_f32 v173, v90, v91
    v_cvt_pk_bf16_f32 v174, v92, v93
    v_cvt_pk_bf16_f32 v175, v94, v95
    v_mfma_f32_32x32x16_bf16 v[80:95], v[132:135], v[8:11], 0
    v_exp_f32 v64, v64
    ds_read_b128 v[128:131], v176 offset:30144
    v_exp_f32 v65, v65
    ds_read_b128 v[152:155], v179 offset:24960
    v_exp_f32 v66, v66
    ds_read_b128 v[156:159], v180 offset:24960
    v_exp_f32 v67, v67
    v_mfma_f32_32x32x16_bf16 v[112:127], v[136:139], v[168:171], v[112:127]
    v_exp_f32 v68, v68
    s_add_u32 m0, s86, 37888
    v_exp_f32 v69, v69
    buffer_load_dwordx4 v233, s[12:15], s89 offen lds
    v_cvt_pk_bf16_f32 v160, v64, v65
    v_exp_f32 v70, v70
    v_exp_f32 v71, v71
    v_cvt_pk_bf16_f32 v161, v66, v67
    v_exp_f32 v72, v72
    v_mfma_f32_32x32x16_bf16 v[112:127], v[140:143], v[172:175], v[112:127]
    v_exp_f32 v73, v73
    buffer_load_dwordx4 a[52:55], v1, s[48:51], s90 offen offset:1024 sc1
    v_cvt_pk_bf16_f32 v162, v68, v69
    v_exp_f32 v74, v74
    v_exp_f32 v75, v75
    v_cvt_pk_bf16_f32 v163, v70, v71
    v_exp_f32 v76, v76
    s_add_u32 m0, s86, 38912
    v_exp_f32 v77, v77
    buffer_load_dwordx4 v234, s[12:15], s89 offen lds
    v_cvt_pk_bf16_f32 v164, v72, v73
    v_exp_f32 v78, v78
    s_waitcnt lgkmcnt(2)
    v_exp_f32 v79, v79
    v_cvt_pk_bf16_f32 v165, v74, v75
    v_cvt_pk_bf16_f32 v166, v76, v77
    v_cvt_pk_bf16_f32 v167, v78, v79
    v_mfma_f32_32x32x16_bf16 v[64:79], v[128:131], v[8:11], 0
    v_exp_f32 v80, v80
    v_exp_f32 v81, v81
    ds_read_b128 v[136:139], v179 offset:29120
    v_exp_f32 v82, v82
    ds_read_b128 v[140:143], v180 offset:29120
    v_exp_f32 v83, v83
    v_mfma_f32_32x32x16_bf16 v[112:127], v[144:147], v[160:163], v[112:127]
    v_exp_f32 v84, v84
    v_exp_f32 v85, v85
    buffer_load_dwordx4 a[24:27], v1, s[48:51], s83 offen offset:2048 sc1
    v_cvt_pk_bf16_f32 v168, v80, v81
    v_exp_f32 v86, v86
    v_exp_f32 v87, v87
    v_cvt_pk_bf16_f32 v169, v82, v83
    v_exp_f32 v88, v88
    s_waitcnt vmcnt(12)
    v_xor_b32 v231, s59, v212
    v_bitop3_b32 v231, v231, v213, s59 bitop3:0xf6
    v_bitop3_b32 v231, v231, v214, s59 bitop3:0xf6
    v_bitop3_b32 v231, v231, v215, s59 bitop3:0xf6
    v_cmp_ne_u32 vcc, 0, v231
    s_cbranch_vccz L_seen_22
L_poll_23:
    buffer_load_dwordx4 v[212:215], v1, s[48:51], s74 offen sc1
    s_waitcnt vmcnt(0)
    v_xor_b32 v231, s59, v212
    v_bitop3_b32 v231, v231, v213, s59 bitop3:0xf6
    v_bitop3_b32 v231, v231, v214, s59 bitop3:0xf6
    v_bitop3_b32 v231, v231, v215, s59 bitop3:0xf6
    v_cmp_ne_u32 vcc, 0, v231
    s_cbranch_vccz L_polled_24
    s_cmp_eq_u32 s61, 0
    s_cbranch_scc1 L_polled_24
    s_sub_u32 s61, s61, 1
    s_sleep 4
    s_branch L_poll_23
L_polled_24:
L_seen_22:
    v_mfma_f32_32x32x16_bf16 v[112:127], v[148:151], v[164:167], v[112:127]
    v_exp_f32 v89, v89
    v_cvt_pk_bf16_f32 v170, v84, v85
    v_exp_f32 v90, v90
    v_exp_f32 v91, v91
    v_cvt_pk_bf16_f32 v171, v86, v87
    v_exp_f32 v92, v92
    s_mov_b32 s3, 65536
    v_exp_f32 v93, v93
    buffer_load_dwordx4 v[212:215], v230, s[48:51], s3 offen sc1
    v_cvt_pk_bf16_f32 v172, v88, v89
    v_exp_f32 v94, v94
    v_exp_f32 v95, v95
    v_cvt_pk_bf16_f32 v173, v90, v91
    v_cvt_pk_bf16_f32 v174, v92, v93
    v_cvt_pk_bf16_f32 v175, v94, v95
    v_exp_f32 v64, v64
    v_exp_f32 v65, v65
    v_exp_f32 v66, v66
    v_exp_f32 v67, v67
    s_waitcnt lgkmcnt(2)
    v_mfma_f32_32x32x16_bf16 v[112:127], v[152:155], v[168:171], v[112:127]
    v_exp_f32 v68, v68
    s_mov_b32 s3, 73728
    v_exp_f32 v69, v69
    buffer_load_dwordx4 v[216:219], v230, s[48:51], s3 offen sc1
    v_cvt_pk_bf16_f32 v160, v64, v65
    v_exp_f32 v70, v70
    v_exp_f32 v71, v71
    v_cvt_pk_bf16_f32 v161, v66, v67
    v_exp_f32 v72, v72
    s_mov_b32 s3, 81920
    v_mfma_f32_32x32x16_bf16 v[112:127], v[156:159], v[172:175], v[112:127]
    buffer_load_dwordx4 v[220:223], v230, s[48:51], s3 offen sc1
    s_barrier
    ds_read_b128 v[132:135], v176 offset:8320
    ds_read_b128 v[128:131], v176 offset:12480
    ds_read_b128 v[144:147], v177 offset:8320
    ds_read_b128 v[148:151], v178 offset:8320
    v_exp_f32 v73, v73
    v_cvt_pk_bf16_f32 v162, v68, v69
    v_exp_f32 v74, v74
    v_exp_f32 v75, v75
    v_cvt_pk_bf16_f32 v163, v70, v71
    v_exp_f32 v76, v76
    s_mov_b32 s3, 90112
    v_exp_f32 v77, v77
    buffer_load_dwordx4 v[224:227], v230, s[48:51], s3 offen sc1
    v_cvt_pk_bf16_f32 v164, v72, v73
    v_exp_f32 v78, v78
    v_exp_f32 v79, v79
    v_cvt_pk_bf16_f32 v165, v74, v75
    s_waitcnt lgkmcnt(3)
    v_mfma_f32_32x32x16_bf16 v[80:95], v[132:135], v[4:7], v[16:31]
    v_cvt_pk_bf16_f32 v166, v76, v77
    v_cvt_pk_bf16_f32 v167, v78, v79
    s_waitcnt lgkmcnt(2)
    v_mfma_f32_32x32x16_bf16 v[64:79], v[128:131], v[4:7], 0
    s_nop 7
    v_exp_f32 v80, v80
    ds_read_b128 v[132:135], v176 offset:5184
    v_exp_f32 v81, v81
    ds_read_b128 v[152:155], v177 offset:12480
    v_exp_f32 v82, v82
    ds_read_b128 v[156:159], v178 offset:12480
    v_exp_f32 v83, v83
    v_mfma_f32_32x32x16_bf16 v[112:127], v[136:139], v[160:163], v[112:127]
    v_exp_f32 v84, v84
    s_add_u32 s89, s22, 4
    s_and_b32 s89, s89, 7
    s_mul_i32 s89, s89, 176128
    s_add_u32 s89, s89, s85
    s_add_u32 m0, s86, 49152
    v_exp_f32 v85, v85
    buffer_load_dwordx4 v232, s[12:15], s89 offen lds
    v_cvt_pk_bf16_f32 v168, v80, v81
    v_exp_f32 v86, v86
    v_exp_f32 v87, v87
    v_cvt_pk_bf16_f32 v169, v82, v83
    v_exp_f32 v88, v88
    v_mfma_f32_32x32x16_bf16 v[112:127], v[140:143], v[164:167], v[112:127]
    v_exp_f32 v89, v89
    buffer_load_dwordx4 a[56:59], v1, s[48:51], s90 offen offset:2048 sc1
    v_cvt_pk_bf16_f32 v170, v84, v85
    v_exp_f32 v90, v90
    v_exp_f32 v91, v91
    v_cvt_pk_bf16_f32 v171, v86, v87
    v_exp_f32 v92, v92
    s_add_u32 m0, s86, 50176
    v_exp_f32 v93, v93
    buffer_load_dwordx4 v233, s[12:15], s89 offen lds
    v_cvt_pk_bf16_f32 v172, v88, v89
    v_exp_f32 v94, v94
    s_waitcnt lgkmcnt(2)
    v_exp_f32 v95, v95
    v_cvt_pk_bf16_f32 v173, v90, v91
    v_cvt_pk_bf16_f32 v174, v92, v93
    v_cvt_pk_bf16_f32 v175, v94, v95
    v_mfma_f32_32x32x16_bf16 v[80:95], v[132:135], v[8:11], v[16:31]
    v_exp_f32 v64, v64
    ds_read_b128 v[128:131], v176 offset:9344
    v_exp_f32 v65, v65
    ds_read_b128 v[136:139], v179 offset:4160
    v_exp_f32 v66, v66
    ds_read_b128 v[140:143], v180 offset:4160
    v_exp_f32 v67, v67
    v_mfma_f32_32x32x16_bf16 v[96:111], v[144:147], v[168:171], v[96:111]
    v_exp_f32 v68, v68
    v_exp_f32 v69, v69
    buffer_load_dwordx4 a[28:31], v1, s[48:51], s83 offen offset:3072 sc1
    v_cvt_pk_bf16_f32 v160, v64, v65
    v_exp_f32 v70, v70
    v_exp_f32 v71, v71
    v_cvt_pk_bf16_f32 v161, v66, v67
    v_exp_f32 v72, v72
    s_add_u32 m0, s86, 51200
    v_mfma_f32_32x32x16_bf16 v[96:111], v[148:151], v[172:175], v[96:111]
    v_exp_f32 v73, v73
    buffer_load_dwordx4 v234, s[12:15], s89 offen lds
    v_cvt_pk_bf16_f32 v162, v68, v69
    v_exp_f32 v74, v74
    v_exp_f32 v75, v75
    v_cvt_pk_bf16_f32 v163, v70, v71
    v_exp_f32 v76, v76
    v_exp_f32 v77, v77
    buffer_load_dwordx4 a[60:63], v1, s[48:51], s90 offen offset:3072 sc1
    v_cvt_pk_bf16_f32 v164, v72, v73
    v_exp_f32 v78, v78
    s_waitcnt lgkmcnt(2)
    v_exp_f32 v79, v79
    v_cvt_pk_bf16_f32 v165, v74, v75
    v_cvt_pk_bf16_f32 v166, v76, v77
    v_cvt_pk_bf16_f32 v167, v78, v79
    v_mfma_f32_32x32x16_bf16 v[64:79], v[128:131], v[8:11], 0
    v_exp_f32 v80, v80
    ds_read_b128 v[132:135], v176 offset:13504
    v_exp_f32 v81, v81
    ds_read_b128 v[144:147], v179 offset:8320
    v_exp_f32 v82, v82
    ds_read_b128 v[148:151], v180 offset:8320
    v_exp_f32 v83, v83
    v_mfma_f32_32x32x16_bf16 v[96:111], v[152:155], v[160:163], v[96:111]
    v_exp_f32 v84, v84
    s_add_u32 s89, s22, 5
    s_and_b32 s89, s89, 7
    s_mul_i32 s89, s89, 176128
    s_add_u32 s89, s89, s85
    s_add_u32 m0, s86, 61440
    v_exp_f32 v85, v85
    buffer_load_dwordx4 v232, s[12:15], s89 offen lds
    v_cvt_pk_bf16_f32 v168, v80, v81
    v_exp_f32 v86, v86
    v_exp_f32 v87, v87
    v_cvt_pk_bf16_f32 v169, v82, v83
    v_exp_f32 v88, v88
    s_add_u32 m0, s86, 62464
    v_mfma_f32_32x32x16_bf16 v[96:111], v[156:159], v[164:167], v[96:111]
    v_exp_f32 v89, v89
    buffer_load_dwordx4 v233, s[12:15], s89 offen lds
    v_cvt_pk_bf16_f32 v170, v84, v85
    v_exp_f32 v90, v90
    v_exp_f32 v91, v91
    v_cvt_pk_bf16_f32 v171, v86, v87
    v_exp_f32 v92, v92
    s_add_u32 m0, s86, 63488
    v_exp_f32 v93, v93
    buffer_load_dwordx4 v234, s[12:15], s89 offen lds
    v_cvt_pk_bf16_f32 v172, v88, v89
    v_exp_f32 v94, v94
    s_waitcnt lgkmcnt(2)
    v_exp_f32 v95, v95
    v_cvt_pk_bf16_f32 v173, v90, v91
    v_cvt_pk_bf16_f32 v174, v92, v93
    v_cvt_pk_bf16_f32 v175, v94, v95
    v_mfma_f32_32x32x16_bf16 v[80:95], v[132:135], v[8:11], 0
    v_exp_f32 v64, v64
    v_exp_f32 v65, v65
    ds_read_b128 v[152:155], v179 offset:12480
    v_exp_f32 v66, v66
    ds_read_b128 v[156:159], v180 offset:12480
    v_exp_f32 v67, v67
    v_mfma_f32_32x32x16_bf16 v[112:127], v[136:139], v[168:171], v[112:127]
    v_exp_f32 v68, v68
    v_exp_f32 v69, v69
    buffer_load_dwordx4 a[64:67], v1, s[48:51], s84 offen sc1
    v_cvt_pk_bf16_f32 v160, v64, v65
    v_exp_f32 v70, v70
    v_exp_f32 v71, v71
    v_cvt_pk_bf16_f32 v161, v66, v67
    v_exp_f32 v72, v72
    v_mfma_f32_32x32x16_bf16 v[112:127], v[140:143], v[172:175], v[112:127]
    v_exp_f32 v73, v73
    buffer_load_dwordx4 a[152:155], v1, s[48:51], s91 offen sc1
    v_cvt_pk_bf16_f32 v162, v68, v69
    v_exp_f32 v74, v74
    v_exp_f32 v75, v75
    v_cvt_pk_bf16_f32 v163, v70, v71
    v_exp_f32 v76, v76
    v_exp_f32 v77, v77
    buffer_load_dwordx4 a[68:71], v1, s[48:51], s84 offen offset:1024 sc1
    v_cvt_pk_bf16_f32 v164, v72, v73
    v_exp_f32 v78, v78
    v_exp_f32 v79, v79
    v_cvt_pk_bf16_f32 v165, v74, v75
    v_cvt_pk_bf16_f32 v166, v76, v77
    v_cvt_pk_bf16_f32 v167, v78, v79
    v_exp_f32 v80, v80
    v_exp_f32 v81, v81
    v_exp_f32 v82, v82
    v_exp_f32 v83, v83
    s_waitcnt lgkmcnt(2)
    v_mfma_f32_32x32x16_bf16 v[112:127], v[144:147], v[160:163], v[112:127]
    v_exp_f32 v84, v84
    v_exp_f32 v85, v85
    v_cvt_pk_bf16_f32 v168, v80, v81
    v_exp_f32 v86, v86
    v_exp_f32 v87, v87
    v_cvt_pk_bf16_f32 v169, v82, v83
    v_exp_f32 v88, v88
    v_mfma_f32_32x32x16_bf16 v[112:127], v[148:151], v[164:167], v[112:127]
    v_exp_f32 v89, v89
    v_cvt_pk_bf16_f32 v170, v84, v85
    v_exp_f32 v90, v90
    v_exp_f32 v91, v91
    v_cvt_pk_bf16_f32 v171, v86, v87
    v_exp_f32 v92, v92
    v_exp_f32 v93, v93
    v_cvt_pk_bf16_f32 v172, v88, v89
    v_exp_f32 v94, v94
    v_exp_f32 v95, v95
    v_cvt_pk_bf16_f32 v173, v90, v91
    v_cvt_pk_bf16_f32 v174, v92, v93
    v_cvt_pk_bf16_f32 v175, v94, v95
    s_waitcnt lgkmcnt(0)
    v_mfma_f32_32x32x16_bf16 v[112:127], v[152:155], v[168:171], v[112:127]
    v_mfma_f32_32x32x16_bf16 v[112:127], v[156:159], v[172:175], v[112:127]
    s_branch L_att_done
L_att3:
    ds_read_b128 v[128:131], v176 offset:33280
    ds_read_b128 v[132:135], v176 offset:37440
    ds_read_b128 v[136:139], v177 offset:33280
    ds_read_b128 v[140:143], v178 offset:33280
    s_waitcnt lgkmcnt(4)
    s_waitcnt lgkmcnt(3)
    v_mfma_f32_32x32x16_bf16 v[64:79], v[128:131], v[4:7], 0
    s_waitcnt lgkmcnt(2)
    v_mfma_f32_32x32x16_bf16 v[80:95], v[132:135], v[4:7], 0
    s_add_u32 s89, s22, 0
    s_and_b32 s89, s89, 7
    s_mul_i32 s89, s89, 176128
    s_add_u32 s89, s89, s85
    s_add_u32 m0, s86, 0
    s_nop 0
    buffer_load_dwordx4 v232, s[12:15], s89 offen lds
    s_add_u32 m0, s86, 1024
    s_nop 0
    buffer_load_dwordx4 v233, s[12:15], s89 offen lds
    s_add_u32 m0, s86, 2048
    s_nop 0
    buffer_load_dwordx4 v234, s[12:15], s89 offen lds
L_poll_25:
    buffer_load_dword v15, v222, s[48:51], s69 offen sc1
    buffer_load_dwordx4 v[212:215], v1, s[48:51], s25 offen sc1
    s_waitcnt vmcnt(0)
    v_xor_b32 v15, s59, v15
    v_bitop3_b32 v15, v15, v212, s59 bitop3:0xf6
    v_bitop3_b32 v15, v15, v213, s59 bitop3:0xf6
    v_bitop3_b32 v15, v15, v214, s59 bitop3:0xf6
    v_bitop3_b32 v15, v15, v215, s59 bitop3:0xf6
    v_cmp_ne_u32 vcc, 0, v15
    s_cbranch_vccz L_polled_26
    s_cmp_eq_u32 s61, 0
    s_cbranch_scc1 L_polled_26
    s_sub_u32 s61, s61, 1
    s_sleep 1
    s_branch L_poll_25
L_polled_26:
    s_add_u32 m0, s52, 114944
    s_nop 0
    buffer_load_dwordx4 v1, s[48:51], s18 offen sc1 lds
    s_add_u32 m0, s52, 114944
    s_nop 0
    buffer_load_dwordx4 v1, s[48:51], s18 offen offset:1024 sc1 lds
    v_exp_f32 v64, v64
    ds_read_b128 v[128:131], v176 offset:41600
    v_exp_f32 v65, v65
    ds_read_b128 v[144:147], v177 offset:37440
    v_exp_f32 v66, v66
    ds_read_b128 v[148:151], v178 offset:37440
    v_exp_f32 v67, v67
    v_exp_f32 v68, v68
    s_add_u32 m0, s52, 114944
    v_exp_f32 v69, v69
    buffer_load_dwordx4 v1, s[48:51], s18 offen offset:2048 sc1 lds
    v_cvt_pk_bf16_f32 v160, v64, v65
    v_exp_f32 v70, v70
    v_exp_f32 v71, v71
    v_cvt_pk_bf16_f32 v161, v66, v67
    v_exp_f32 v72, v72
    v_exp_f32 v73, v73
    v_cvt_pk_bf16_f32 v162, v68, v69
    v_exp_f32 v74, v74
    v_exp_f32 v75, v75
    v_cvt_pk_bf16_f32 v163, v70, v71
    v_exp_f32 v76, v76
    s_add_u32 m0, s52, 114944
    v_exp_f32 v77, v77
    buffer_load_dwordx4 v1, s[48:51], s18 offen offset:3072 sc1 lds
    v_cvt_pk_bf16_f32 v164, v72, v73
    v_exp_f32 v78, v78
    s_waitcnt lgkmcnt(2)
    v_exp_f32 v79, v79
    v_cvt_pk_bf16_f32 v165, v74, v75
    v_cvt_pk_bf16_f32 v166, v76, v77
    v_cvt_pk_bf16_f32 v167, v78, v79
    v_mfma_f32_32x32x16_bf16 v[64:79], v[128:131], v[4:7], 0
    v_exp_f32 v80, v80
    ds_read_b128 v[132:135], v176 offset:45760
    v_exp_f32 v81, v81
    ds_read_b128 v[152:155], v177 offset:41600
    v_exp_f32 v82, v82
    ds_read_b128 v[156:159], v178 offset:41600
    v_exp_f32 v83, v83
    v_mfma_f32_32x32x16_bf16 v[96:111], v[136:139], v[160:163], 0
    v_exp_f32 v84, v84
    s_add_u32 m0, s52, 98304
    v_exp_f32 v85, v85
    buffer_load_dwordx4 v1, s[48:51], s19 offen sc1 lds
    v_cvt_pk_bf16_f32 v168, v80, v81
    v_exp_f32 v86, v86
    v_exp_f32 v87, v87
    v_cvt_pk_bf16_f32 v169, v82, v83
    v_exp_f32 v88, v88
    v_mfma_f32_32x32x16_bf16 v[96:111], v[140:143], v[164:167], v[96:111]
    v_exp_f32 v89, v89
    v_cvt_pk_bf16_f32 v170, v84, v85
    v_exp_f32 v90, v90
    v_exp_f32 v91, v91
    v_cvt_pk_bf16_f32 v171, v86, v87
    v_exp_f32 v92, v92
    s_add_u32 m0, s52, 98304
    v_exp_f32 v93, v93
    buffer_load_dwordx4 v1, s[48:51], s19 offen offset:1024 sc1 lds
    v_cvt_pk_bf16_f32 v172, v88, v89
    v_exp_f32 v94, v94
    s_waitcnt lgkmcnt(2)
    v_exp_f32 v95, v95
    v_cvt_pk_bf16_f32 v173, v90, v91
    v_cvt_pk_bf16_f32 v174, v92, v93
    v_cvt_pk_bf16_f32 v175, v94, v95
    v_mfma_f32_32x32x16_bf16 v[80:95], v[132:135], v[4:7], v[48:63]
    v_exp_f32 v64, v64
    ds_read_b128 v[128:131], v176 offset:34304
    v_exp_f32 v65, v65
    ds_read_b128 v[136:139], v177 offset:45760
    v_exp_f32 v66, v66
    ds_read_b128 v[140:143], v178 offset:45760
    v_exp_f32 v67, v67
    v_mfma_f32_32x32x16_bf16 v[96:111], v[144:147], v[168:171], v[96:111]
    v_exp_f32 v68, v68
    s_add_u32 m0, s52, 98304
    v_exp_f32 v69, v69
    buffer_load_dwordx4 v1, s[48:51], s19 offen offset:2048 sc1 lds
    v_cvt_pk_bf16_f32 v160, v64, v65
    v_exp_f32 v70, v70
    v_exp_f32 v71, v71
    v_cvt_pk_bf16_f32 v161, v66, v67
    v_exp_f32 v72, v72
    v_mfma_f32_32x32x16_bf16 v[96:111], v[148:151], v[172:175], v[96:111]
    v_exp_f32 v73, v73
    v_cvt_pk_bf16_f32 v162, v68, v69
    v_exp_f32 v74, v74
    v_exp_f32 v75, v75
    v_cvt_pk_bf16_f32 v163, v70, v71
    v_exp_f32 v76, v76
    s_add_u32 m0, s52, 98304
    v_exp_f32 v77, v77
    buffer_load_dwordx4 v1, s[48:51], s19 offen offset:3072 sc1 lds
    v_cvt_pk_bf16_f32 v164, v72, v73
    v_exp_f32 v78, v78
    s_waitcnt lgkmcnt(2)
    v_exp_f32 v79, v79
    v_cvt_pk_bf16_f32 v165, v74, v75
    v_cvt_pk_bf16_f32 v166, v76, v77
    v_cvt_pk_bf16_f32 v167, v78, v79
    v_mfma_f32_32x32x16_bf16 v[64:79], v[128:131], v[8:11], v[48:63]
    v_exp_f32 v80, v80
    v_exp_f32 v81, v81
    ds_read_b128 v[144:147], v179 offset:33280
    v_exp_f32 v82, v82
    ds_read_b128 v[148:151], v180 offset:33280
    v_exp_f32 v83, v83
    v_mfma_f32_32x32x16_bf16 v[96:111], v[152:155], v[160:163], v[96:111]
    v_exp_f32 v84, v84
    s_mov_b64 exec, 2
    buffer_store_dword v14, v13, s[48:51], s64 offen sc1
    s_mov_b64 exec, -1
    v_exp_f32 v85, v85
    v_cvt_pk_bf16_f32 v168, v80, v81
    v_exp_f32 v86, v86
    v_exp_f32 v87, v87
    v_cvt_pk_bf16_f32 v169, v82, v83
    v_exp_f32 v88, v88
    v_mfma_f32_32x32x16_bf16 v[96:111], v[156:159], v[164:167], v[96:111]
    v_exp_f32 v89, v89
    v_cvt_pk_bf16_f32 v170, v84, v85
    v_exp_f32 v90, v90
    v_exp_f32 v91, v91
    v_cvt_pk_bf16_f32 v171, v86, v87
    v_exp_f32 v92, v92
    v_exp_f32 v93, v93
    v_cvt_pk_bf16_f32 v172, v88, v89
    v_exp_f32 v94, v94
    v_exp_f32 v95, v95
    v_cvt_pk_bf16_f32 v173, v90, v91
    v_cvt_pk_bf16_f32 v174, v92, v93
    v_cvt_pk_bf16_f32 v175, v94, v95
    v_exp_f32 v64, v64
    v_exp_f32 v65, v65
    v_exp_f32 v66, v66
    v_exp_f32 v67, v67
    s_waitcnt lgkmcnt(2)
    v_mfma_f32_32x32x16_bf16 v[96:111], v[136:139], v[168:171], v[96:111]
    v_exp_f32 v68, v68
    v_exp_f32 v69, v69
    buffer_load_dwordx4 a[0:3], v1, s[48:51], s83 offen sc1
    v_cvt_pk_bf16_f32 v160, v64, v65
    v_exp_f32 v70, v70
    v_exp_f32 v71, v71
    v_cvt_pk_bf16_f32 v161, v66, v67
    v_exp_f32 v72, v72
    v_mfma_f32_32x32x16_bf16 v[96:111], v[140:143], v[172:175], v[96:111]
    s_waitcnt vmcnt(6)
    s_barrier
    ds_read_b128 v[132:135], v176 offset:16640
    ds_read_b128 v[128:131], v176 offset:20800
    ds_read_b128 v[152:155], v177 offset:16640
    ds_read_b128 v[156:159], v178 offset:16640
    v_exp_f32 v73, v73
    v_cvt_pk_bf16_f32 v162, v68, v69
    v_exp_f32 v74, v74
    v_exp_f32 v75, v75
    v_cvt_pk_bf16_f32 v163, v70, v71
    v_exp_f32 v76, v76
    v_exp_f32 v77, v77
    v_cvt_pk_bf16_f32 v164, v72, v73
    v_exp_f32 v78, v78
    v_exp_f32 v79, v79
    v_cvt_pk_bf16_f32 v165, v74, v75
    s_waitcnt lgkmcnt(3)
    v_mfma_f32_32x32x16_bf16 v[80:95], v[132:135], v[4:7], 0
    v_cvt_pk_bf16_f32 v166, v76, v77
    v_cvt_pk_bf16_f32 v167, v78, v79
    s_waitcnt lgkmcnt(2)
    v_mfma_f32_32x32x16_bf16 v[64:79], v[128:131], v[4:7], 0
    s_nop 7
    v_exp_f32 v80, v80
    ds_read_b128 v[132:135], v176 offset:24960
    v_exp_f32 v81, v81
    ds_read_b128 v[136:139], v177 offset:20800
    v_exp_f32 v82, v82
    ds_read_b128 v[140:143], v178 offset:20800
    v_exp_f32 v83, v83
    v_mfma_f32_32x32x16_bf16 v[112:127], v[144:147], v[160:163], 0
    v_exp_f32 v84, v84
    v_exp_f32 v85, v85
    buffer_load_dwordx4 a[32:35], v1, s[48:51], s90 offen sc1
    v_cvt_pk_bf16_f32 v168, v80, v81
    v_exp_f32 v86, v86
    v_exp_f32 v87, v87
    buffer_load_dwordx4 a[4:7], v1, s[48:51], s83 offen offset:1024 sc1
    v_cvt_pk_bf16_f32 v169, v82, v83
    v_exp_f32 v88, v88
    v_mfma_f32_32x32x16_bf16 v[112:127], v[148:151], v[164:167], v[112:127]
    v_exp_f32 v89, v89
    buffer_load_dwordx4 a[36:39], v1, s[48:51], s90 offen offset:1024 sc1
    v_cvt_pk_bf16_f32 v170, v84, v85
    v_exp_f32 v90, v90
    v_exp_f32 v91, v91
    v_cvt_pk_bf16_f32 v171, v86, v87
    v_exp_f32 v92, v92
    s_add_u32 s89, s22, 1
    s_and_b32 s89, s89, 7
    s_mul_i32 s89, s89, 176128
    s_add_u32 s89, s89, s85
    s_add_u32 m0, s86, 12288
    v_exp_f32 v93, v93
    buffer_load_dwordx4 v232, s[12:15], s89 offen lds
    v_cvt_pk_bf16_f32 v172, v88, v89
    v_exp_f32 v94, v94
    s_waitcnt lgkmcnt(2)
    v_exp_f32 v95, v95
    v_cvt_pk_bf16_f32 v173, v90, v91
    v_cvt_pk_bf16_f32 v174, v92, v93
    v_cvt_pk_bf16_f32 v175, v94, v95
    v_mfma_f32_32x32x16_bf16 v[80:95], v[132:135], v[4:7], 0
    v_exp_f32 v64, v64
    ds_read_b128 v[128:131], v176 offset:29120
    v_exp_f32 v65, v65
    ds_read_b128 v[144:147], v177 offset:24960
    v_exp_f32 v66, v66
    ds_read_b128 v[148:151], v178 offset:24960
    v_exp_f32 v67, v67
    v_mfma_f32_32x32x16_bf16 v[96:111], v[152:155], v[168:171], v[96:111]
    v_exp_f32 v68, v68
    v_exp_f32 v69, v69
    buffer_load_dwordx4 a[8:11], v1, s[48:51], s83 offen offset:2048 sc1
    v_cvt_pk_bf16_f32 v160, v64, v65
    v_exp_f32 v70, v70
    s_add_u32 m0, s86, 13312
    v_exp_f32 v71, v71
    buffer_load_dwordx4 v233, s[12:15], s89 offen lds
    v_cvt_pk_bf16_f32 v161, v66, v67
    v_exp_f32 v72, v72
    v_mfma_f32_32x32x16_bf16 v[96:111], v[156:159], v[172:175], v[96:111]
    v_exp_f32 v73, v73
    buffer_load_dwordx4 a[40:43], v1, s[48:51], s90 offen offset:2048 sc1
    v_cvt_pk_bf16_f32 v162, v68, v69
    v_exp_f32 v74, v74
    v_exp_f32 v75, v75
    v_cvt_pk_bf16_f32 v163, v70, v71
    v_exp_f32 v76, v76
    s_add_u32 m0, s86, 14336
    v_exp_f32 v77, v77
    buffer_load_dwordx4 v234, s[12:15], s89 offen lds
    v_cvt_pk_bf16_f32 v164, v72, v73
    v_exp_f32 v78, v78
    s_waitcnt lgkmcnt(2)
    v_exp_f32 v79, v79
    v_cvt_pk_bf16_f32 v165, v74, v75
    v_cvt_pk_bf16_f32 v166, v76, v77
    v_cvt_pk_bf16_f32 v167, v78, v79
    v_mfma_f32_32x32x16_bf16 v[64:79], v[128:131], v[4:7], 0
    v_exp_f32 v80, v80
    ds_read_b128 v[132:135], v176 offset:17664
    v_exp_f32 v81, v81
    ds_read_b128 v[152:155], v177 offset:29120
    v_exp_f32 v82, v82
    ds_read_b128 v[156:159], v178 offset:29120
    v_exp_f32 v83, v83
    v_mfma_f32_32x32x16_bf16 v[96:111], v[136:139], v[160:163], v[96:111]
    v_exp_f32 v84, v84
    v_exp_f32 v85, v85
    buffer_load_dwordx4 a[12:15], v1, s[48:51], s83 offen offset:3072 sc1
    v_cvt_pk_bf16_f32 v168, v80, v81
    v_exp_f32 v86, v86
    v_exp_f32 v87, v87
    buffer_load_dwordx4 v[212:215], v1, s[48:51], s74 offen sc1
    v_cvt_pk_bf16_f32 v169, v82, v83
    v_exp_f32 v88, v88
    s_add_u32 s89, s22, 2
    s_and_b32 s89, s89, 7
    s_mul_i32 s89, s89, 176128
    s_add_u32 s89, s89, s85
    s_add_u32 m0, s86, 24576
    v_mfma_f32_32x32x16_bf16 v[96:111], v[140:143], v[164:167], v[96:111]
    v_exp_f32 v89, v89
    buffer_load_dwordx4 v232, s[12:15], s89 offen lds
    v_cvt_pk_bf16_f32 v170, v84, v85
    v_exp_f32 v90, v90
    v_exp_f32 v91, v91
    v_cvt_pk_bf16_f32 v171, v86, v87
    v_exp_f32 v92, v92
    v_exp_f32 v93, v93
    buffer_load_dwordx4 a[44:47], v1, s[48:51], s90 offen offset:3072 sc1
    v_cvt_pk_bf16_f32 v172, v88, v89
    v_exp_f32 v94, v94
    s_waitcnt lgkmcnt(2)
    v_exp_f32 v95, v95
    v_cvt_pk_bf16_f32 v173, v90, v91
    v_cvt_pk_bf16_f32 v174, v92, v93
    v_cvt_pk_bf16_f32 v175, v94, v95
    v_mfma_f32_32x32x16_bf16 v[80:95], v[132:135], v[8:11], 0
    v_exp_f32 v64, v64
    ds_read_b128 v[128:131], v176 offset:21824
    v_exp_f32 v65, v65
    ds_read_b128 v[136:139], v179 offset:16640
    v_exp_f32 v66, v66
    ds_read_b128 v[140:143], v180 offset:16640
    v_exp_f32 v67, v67
    v_mfma_f32_32x32x16_bf16 v[96:111], v[144:147], v[168:171], v[96:111]
    v_exp_f32 v68, v68
    s_add_u32 m0, s86, 25600
    v_exp_f32 v69, v69
    buffer_load_dwordx4 v233, s[12:15], s89 offen lds
    v_cvt_pk_bf16_f32 v160, v64, v65
    v_exp_f32 v70, v70
    v_exp_f32 v71, v71
    v_cvt_pk_bf16_f32 v161, v66, v67
    v_exp_f32 v72, v72
    s_add_u32 s83, s83, 4096
    v_mfma_f32_32x32x16_bf16 v[96:111], v[148:151], v[172:175], v[96:111]
    v_exp_f32 v73, v73
    buffer_load_dwordx4 a[16:19], v1, s[48:51], s83 offen sc1
    v_cvt_pk_bf16_f32 v162, v68, v69
    v_exp_f32 v74, v74
    v_exp_f32 v75, v75
    v_cvt_pk_bf16_f32 v163, v70, v71
    v_exp_f32 v76, v76
    s_add_u32 m0, s86, 26624
    v_exp_f32 v77, v77
    buffer_load_dwordx4 v234, s[12:15], s89 offen lds
    v_cvt_pk_bf16_f32 v164, v72, v73
    v_exp_f32 v78, v78
    s_waitcnt lgkmcnt(2)
    v_exp_f32 v79, v79
    v_cvt_pk_bf16_f32 v165, v74, v75
    v_cvt_pk_bf16_f32 v166, v76, v77
    v_cvt_pk_bf16_f32 v167, v78, v79
    v_mfma_f32_32x32x16_bf16 v[64:79], v[128:131], v[8:11], 0
    v_exp_f32 v80, v80
    ds_read_b128 v[132:135], v176 offset:25984
    v_exp_f32 v81, v81
    ds_read_b128 v[144:147], v179 offset:20800
    v_exp_f32 v82, v82
    ds_read_b128 v[148:151], v180 offset:20800
    v_exp_f32 v83, v83
    v_mfma_f32_32x32x16_bf16 v[96:111], v[152:155], v[160:163], v[96:111]
    v_exp_f32 v84, v84
    s_add_u32 s90, s90, 4096
    v_exp_f32 v85, v85
    buffer_load_dwordx4 a[48:51], v1, s[48:51], s90 offen sc1
    v_cvt_pk_bf16_f32 v168, v80, v81
    v_exp_f32 v86, v86
    v_exp_f32 v87, v87
    v_cvt_pk_bf16_f32 v169, v82, v83
    v_exp_f32 v88, v88
    s_add_u32 s89, s22, 3
    s_and_b32 s89, s89, 7
    s_mul_i32 s89, s89, 176128
    s_add_u32 s89, s89, s85
    s_add_u32 m0, s86, 36864
    v_mfma_f32_32x32x16_bf16 v[96:111], v[156:159], v[164:167], v[96:111]
    v_exp_f32 v89, v89
    buffer_load_dwordx4 v232, s[12:15], s89 offen lds
    v_cvt_pk_bf16_f32 v170, v84, v85
    v_exp_f32 v90, v90
    v_exp_f32 v91, v91
    v_cvt_pk_bf16_f32 v171, v86, v87
    v_exp_f32 v92, v92
    v_exp_f32 v93, v93
    buffer_load_dwordx4 a[20:23], v1, s[48:51], s83 offen offset:1024 sc1
    v_cvt_pk_bf16_f32 v172, v88, v89
    v_exp_f32 v94, v94
    s_waitcnt lgkmcnt(2)
    v_exp_f32 v95, v95
    v_cvt_pk_bf16_f32 v173, v90, v91
    v_cvt_pk_bf16_f32 v174, v92, v93
    v_cvt_pk_bf16_f32 v175, v94, v95
    v_mfma_f32_32x32x16_bf16 v[80:95], v[132:135], v[8:11], 0
    v_exp_f32 v64, v64
    ds_read_b128 v[128:131], v176 offset:30144
    v_exp_f32 v65, v65
    ds_read_b128 v[152:155], v179 offset:24960
    v_exp_f32 v66, v66
    ds_read_b128 v[156:159], v180 offset:24960
    v_exp_f32 v67, v67
    v_mfma_f32_32x32x16_bf16 v[112:127], v[136:139], v[168:171], v[112:127]
    v_exp_f32 v68, v68
    s_add_u32 m0, s86, 37888
    v_exp_f32 v69, v69
    buffer_load_dwordx4 v233, s[12:15], s89 offen lds
    v_cvt_pk_bf16_f32 v160, v64, v65
    v_exp_f32 v70, v70
    v_exp_f32 v71, v71
    v_cvt_pk_bf16_f32 v161, v66, v67
    v_exp_f32 v72, v72
    v_mfma_f32_32x32x16_bf16 v[112:127], v[140:143], v[172:175], v[112:127]
    v_exp_f32 v73, v73
    buffer_load_dwordx4 a[52:55], v1, s[48:51], s90 offen offset:1024 sc1
    v_cvt_pk_bf16_f32 v162, v68, v69
    v_exp_f32 v74, v74
    v_exp_f32 v75, v75
    v_cvt_pk_bf16_f32 v163, v70, v71
    v_exp_f32 v76, v76
    s_add_u32 m0, s86, 38912
    v_exp_f32 v77, v77
    buffer_load_dwordx4 v234, s[12:15], s89 offen lds
    v_cvt_pk_bf16_f32 v164, v72, v73
    v_exp_f32 v78, v78
    s_waitcnt lgkmcnt(2)
    v_exp_f32 v79, v79
    v_cvt_pk_bf16_f32 v165, v74, v75
    v_cvt_pk_bf16_f32 v166, v76, v77
    v_cvt_pk_bf16_f32 v167, v78, v79
    v_mfma_f32_32x32x16_bf16 v[64:79], v[128:131], v[8:11], 0
    v_exp_f32 v80, v80
    v_exp_f32 v81, v81
    ds_read_b128 v[136:139], v179 offset:29120
    v_exp_f32 v82, v82
    ds_read_b128 v[140:143], v180 offset:29120
    v_exp_f32 v83, v83
    v_mfma_f32_32x32x16_bf16 v[112:127], v[144:147], v[160:163], v[112:127]
    v_exp_f32 v84, v84
    v_exp_f32 v85, v85
    buffer_load_dwordx4 a[24:27], v1, s[48:51], s83 offen offset:2048 sc1
    v_cvt_pk_bf16_f32 v168, v80, v81
    v_exp_f32 v86, v86
    v_exp_f32 v87, v87
    v_cvt_pk_bf16_f32 v169, v82, v83
    v_exp_f32 v88, v88
    s_waitcnt vmcnt(12)
    v_xor_b32 v231, s59, v212
    v_bitop3_b32 v231, v231, v213, s59 bitop3:0xf6
    v_bitop3_b32 v231, v231, v214, s59 bitop3:0xf6
    v_bitop3_b32 v231, v231, v215, s59 bitop3:0xf6
    v_cmp_ne_u32 vcc, 0, v231
    s_cbranch_vccz L_seen_27
L_poll_28:
    buffer_load_dwordx4 v[212:215], v1, s[48:51], s74 offen sc1
    s_waitcnt vmcnt(0)
    v_xor_b32 v231, s59, v212
    v_bitop3_b32 v231, v231, v213, s59 bitop3:0xf6
    v_bitop3_b32 v231, v231, v214, s59 bitop3:0xf6
    v_bitop3_b32 v231, v231, v215, s59 bitop3:0xf6
    v_cmp_ne_u32 vcc, 0, v231
    s_cbranch_vccz L_polled_29
    s_cmp_eq_u32 s61, 0
    s_cbranch_scc1 L_polled_29
    s_sub_u32 s61, s61, 1
    s_sleep 4
    s_branch L_poll_28
L_polled_29:
L_seen_27:
    v_mfma_f32_32x32x16_bf16 v[112:127], v[148:151], v[164:167], v[112:127]
    v_exp_f32 v89, v89
    v_cvt_pk_bf16_f32 v170, v84, v85
    v_exp_f32 v90, v90
    v_exp_f32 v91, v91
    v_cvt_pk_bf16_f32 v171, v86, v87
    v_exp_f32 v92, v92
    s_mov_b32 s3, 65536
    v_exp_f32 v93, v93
    buffer_load_dwordx4 v[212:215], v230, s[48:51], s3 offen sc1
    v_cvt_pk_bf16_f32 v172, v88, v89
    v_exp_f32 v94, v94
    v_exp_f32 v95, v95
    v_cvt_pk_bf16_f32 v173, v90, v91
    v_cvt_pk_bf16_f32 v174, v92, v93
    v_cvt_pk_bf16_f32 v175, v94, v95
    v_exp_f32 v64, v64
    v_exp_f32 v65, v65
    v_exp_f32 v66, v66
    v_exp_f32 v67, v67
    s_waitcnt lgkmcnt(2)
    v_mfma_f32_32x32x16_bf16 v[112:127], v[152:155], v[168:171], v[112:127]
    v_exp_f32 v68, v68
    s_mov_b32 s3, 73728
    v_exp_f32 v69, v69
    buffer_load_dwordx4 v[216:219], v230, s[48:51], s3 offen sc1
    v_cvt_pk_bf16_f32 v160, v64, v65
    v_exp_f32 v70, v70
    v_exp_f32 v71, v71
    v_cvt_pk_bf16_f32 v161, v66, v67
    v_exp_f32 v72, v72
    s_mov_b32 s3, 81920
    v_mfma_f32_32x32x16_bf16 v[112:127], v[156:159], v[172:175], v[112:127]
    buffer_load_dwordx4 v[220:223], v230, s[48:51], s3 offen sc1
    s_barrier
    ds_read_b128 v[132:135], v176 offset:12480
    ds_read_b128 v[128:131], v176 offset:1024
    ds_read_b128 v[144:147], v177 offset:12480
    ds_read_b128 v[148:151], v178 offset:12480
    v_exp_f32 v73, v73
    v_cvt_pk_bf16_f32 v162, v68, v69
    v_exp_f32 v74, v74
    v_exp_f32 v75, v75
    v_cvt_pk_bf16_f32 v163, v70, v71
    v_exp_f32 v76, v76
    s_mov_b32 s3, 90112
    v_exp_f32 v77, v77
    buffer_load_dwordx4 v[224:227], v230, s[48:51], s3 offen sc1
    v_cvt_pk_bf16_f32 v164, v72, v73
    v_exp_f32 v78, v78
    v_exp_f32 v79, v79
    v_cvt_pk_bf16_f32 v165, v74, v75
    s_waitcnt lgkmcnt(3)
    v_mfma_f32_32x32x16_bf16 v[80:95], v[132:135], v[4:7], v[16:31]
    v_cvt_pk_bf16_f32 v166, v76, v77
    v_cvt_pk_bf16_f32 v167, v78, v79
    s_waitcnt lgkmcnt(2)
    v_mfma_f32_32x32x16_bf16 v[64:79], v[128:131], v[8:11], v[16:31]
    s_nop 7
    v_exp_f32 v80, v80
    ds_read_b128 v[132:135], v176 offset:5184
    v_exp_f32 v81, v81
    ds_read_b128 v[152:155], v179 offset:0
    v_exp_f32 v82, v82
    ds_read_b128 v[156:159], v180 offset:0
    v_exp_f32 v83, v83
    v_mfma_f32_32x32x16_bf16 v[112:127], v[136:139], v[160:163], v[112:127]
    v_exp_f32 v84, v84
    s_add_u32 s89, s22, 4
    s_and_b32 s89, s89, 7
    s_mul_i32 s89, s89, 176128
    s_add_u32 s89, s89, s85
    s_add_u32 m0, s86, 49152
    v_exp_f32 v85, v85
    buffer_load_dwordx4 v232, s[12:15], s89 offen lds
    v_cvt_pk_bf16_f32 v168, v80, v81
    v_exp_f32 v86, v86
    v_exp_f32 v87, v87
    v_cvt_pk_bf16_f32 v169, v82, v83
    v_exp_f32 v88, v88
    v_mfma_f32_32x32x16_bf16 v[112:127], v[140:143], v[164:167], v[112:127]
    v_exp_f32 v89, v89
    buffer_load_dwordx4 a[56:59], v1, s[48:51], s90 offen offset:2048 sc1
    v_cvt_pk_bf16_f32 v170, v84, v85
    v_exp_f32 v90, v90
    v_exp_f32 v91, v91
    v_cvt_pk_bf16_f32 v171, v86, v87
    v_exp_f32 v92, v92
    s_add_u32 m0, s86, 50176
    v_exp_f32 v93, v93
    buffer_load_dwordx4 v233, s[12:15], s89 offen lds
    v_cvt_pk_bf16_f32 v172, v88, v89
    v_exp_f32 v94, v94
    s_waitcnt lgkmcnt(2)
    v_exp_f32 v95, v95
    v_cvt_pk_bf16_f32 v173, v90, v91
    v_cvt_pk_bf16_f32 v174, v92, v93
    v_cvt_pk_bf16_f32 v175, v94, v95
    v_mfma_f32_32x32x16_bf16 v[80:95], v[132:135], v[8:11], 0
    v_exp_f32 v64, v64
    ds_read_b128 v[128:131], v176 offset:9344
    v_exp_f32 v65, v65
    ds_read_b128 v[136:139], v179 offset:4160
    v_exp_f32 v66, v66
    ds_read_b128 v[140:143], v180 offset:4160
    v_exp_f32 v67, v67
    v_mfma_f32_32x32x16_bf16 v[96:111], v[144:147], v[168:171], v[96:111]
    v_exp_f32 v68, v68
    v_exp_f32 v69, v69
    buffer_load_dwordx4 a[28:31], v1, s[48:51], s83 offen offset:3072 sc1
    v_cvt_pk_bf16_f32 v160, v64, v65
    v_exp_f32 v70, v70
    v_exp_f32 v71, v71
    v_cvt_pk_bf16_f32 v161, v66, v67
    v_exp_f32 v72, v72
    s_add_u32 m0, s86, 51200
    v_mfma_f32_32x32x16_bf16 v[96:111], v[148:151], v[172:175], v[96:111]
    v_exp_f32 v73, v73
    buffer_load_dwordx4 v234, s[12:15], s89 offen lds
    v_cvt_pk_bf16_f32 v162, v68, v69
    v_exp_f32 v74, v74
    v_exp_f32 v75, v75
    v_cvt_pk_bf16_f32 v163, v70, v71
    v_exp_f32 v76, v76
    v_exp_f32 v77, v77
    buffer_load_dwordx4 a[60:63], v1, s[48:51], s90 offen offset:3072 sc1
    v_cvt_pk_bf16_f32 v164, v72, v73
    v_exp_f32 v78, v78
    s_waitcnt lgkmcnt(2)
    v_exp_f32 v79, v79
    v_cvt_pk_bf16_f32 v165, v74, v75
    v_cvt_pk_bf16_f32 v166, v76, v77
    v_cvt_pk_bf16_f32 v167, v78, v79
    v_mfma_f32_32x32x16_bf16 v[64:79], v[128:131], v[8:11], 0
    v_exp_f32 v80, v80
    ds_read_b128 v[132:135], v176 offset:13504
    v_exp_f32 v81, v81
    ds_read_b128 v[144:147], v179 offset:8320
    v_exp_f32 v82, v82
    ds_read_b128 v[148:151], v180 offset:8320
    v_exp_f32 v83, v83
    v_mfma_f32_32x32x16_bf16 v[112:127], v[152:155], v[160:163], v[112:127]
    v_exp_f32 v84, v84
    s_add_u32 s89, s22, 5
    s_and_b32 s89, s89, 7
    s_mul_i32 s89, s89, 176128
    s_add_u32 s89, s89, s85
    s_add_u32 m0, s86, 61440
    v_exp_f32 v85, v85
    buffer_load_dwordx4 v232, s[12:15], s89 offen lds
    v_cvt_pk_bf16_f32 v168, v80, v81
    v_exp_f32 v86, v86
    v_exp_f32 v87, v87
    v_cvt_pk_bf16_f32 v169, v82, v83
    v_exp_f32 v88, v88
    s_add_u32 m0, s86, 62464
    v_mfma_f32_32x32x16_bf16 v[112:127], v[156:159], v[164:167], v[112:127]
    v_exp_f32 v89, v89
    buffer_load_dwordx4 v233, s[12:15], s89 offen lds
    v_cvt_pk_bf16_f32 v170, v84, v85
    v_exp_f32 v90, v90
    v_exp_f32 v91, v91
    v_cvt_pk_bf16_f32 v171, v86, v87
    v_exp_f32 v92, v92
    s_add_u32 m0, s86, 63488
    v_exp_f32 v93, v93
    buffer_load_dwordx4 v234, s[12:15], s89 offen lds
    v_cvt_pk_bf16_f32 v172, v88, v89
    v_exp_f32 v94, v94
    s_waitcnt lgkmcnt(2)
    v_exp_f32 v95, v95
    v_cvt_pk_bf16_f32 v173, v90, v91
    v_cvt_pk_bf16_f32 v174, v92, v93
    v_cvt_pk_bf16_f32 v175, v94, v95
    v_mfma_f32_32x32x16_bf16 v[80:95], v[132:135], v[8:11], 0
    v_exp_f32 v64, v64
    v_exp_f32 v65, v65
    ds_read_b128 v[152:155], v179 offset:12480
    v_exp_f32 v66, v66
    ds_read_b128 v[156:159], v180 offset:12480
    v_exp_f32 v67, v67
    v_mfma_f32_32x32x16_bf16 v[112:127], v[136:139], v[168:171], v[112:127]
    v_exp_f32 v68, v68
    v_exp_f32 v69, v69
    buffer_load_dwordx4 a[64:67], v1, s[48:51], s84 offen sc1
    v_cvt_pk_bf16_f32 v160, v64, v65
    v_exp_f32 v70, v70
    v_exp_f32 v71, v71
    v_cvt_pk_bf16_f32 v161, v66, v67
    v_exp_f32 v72, v72
    v_mfma_f32_32x32x16_bf16 v[112:127], v[140:143], v[172:175], v[112:127]
    v_exp_f32 v73, v73
    buffer_load_dwordx4 a[152:155], v1, s[48:51], s91 offen sc1
    v_cvt_pk_bf16_f32 v162, v68, v69
    v_exp_f32 v74, v74
    v_exp_f32 v75, v75
    v_cvt_pk_bf16_f32 v163, v70, v71
    v_exp_f32 v76, v76
    v_exp_f32 v77, v77
    buffer_load_dwordx4 a[68:71], v1, s[48:51], s84 offen offset:1024 sc1
    v_cvt_pk_bf16_f32 v164, v72, v73
    v_exp_f32 v78, v78
    v_exp_f32 v79, v79
    v_cvt_pk_bf16_f32 v165, v74, v75
    v_cvt_pk_bf16_f32 v166, v76, v77
    v_cvt_pk_bf16_f32 v167, v78, v79
    v_exp_f32 v80, v80
    v_exp_f32 v81, v81
    v_exp_f32 v82, v82
    v_exp_f32 v83, v83
    s_waitcnt lgkmcnt(2)
    v_mfma_f32_32x32x16_bf16 v[112:127], v[144:147], v[160:163], v[112:127]
    v_exp_f32 v84, v84
    v_exp_f32 v85, v85
    v_cvt_pk_bf16_f32 v168, v80, v81
    v_exp_f32 v86, v86
    v_exp_f32 v87, v87
    v_cvt_pk_bf16_f32 v169, v82, v83
    v_exp_f32 v88, v88
    v_mfma_f32_32x32x16_bf16 v[112:127], v[148:151], v[164:167], v[112:127]
    v_exp_f32 v89, v89
    v_cvt_pk_bf16_f32 v170, v84, v85
    v_exp_f32 v90, v90
    v_exp_f32 v91, v91
    v_cvt_pk_bf16_f32 v171, v86, v87
    v_exp_f32 v92, v92
    v_exp_f32 v93, v93
    v_cvt_pk_bf16_f32 v172, v88, v89
    v_exp_f32 v94, v94
    v_exp_f32 v95, v95
    v_cvt_pk_bf16_f32 v173, v90, v91
    v_cvt_pk_bf16_f32 v174, v92, v93
    v_cvt_pk_bf16_f32 v175, v94, v95
    s_waitcnt lgkmcnt(0)
    v_mfma_f32_32x32x16_bf16 v[112:127], v[152:155], v[168:171], v[112:127]
    v_mfma_f32_32x32x16_bf16 v[112:127], v[156:159], v[172:175], v[112:127]
L_att_done:
    s_lshl_b32 s3, s58, 11
    s_add_u32 m0, s3, 154624
    s_add_u32 s3, s95, 0
    buffer_load_dwordx4 v229, s[28:31], s3 offen lds
    s_lshl_b32 s3, s58, 11
    s_add_u32 m0, s3, 155648
    s_add_u32 s3, s95, 16384
    buffer_load_dwordx4 v229, s[28:31], s3 offen lds
    v_cmp_lt_f32 vcc, 0x21800000, v104
    v_add_f32_e64 v88, abs(v96), abs(v97)
    v_add_f32_e64 v89, abs(v98), abs(v99)
    s_mov_b64 s[64:65], vcc
    v_cmp_gt_f32 vcc, 0x5d800000, v104
    v_add_f32_e64 v88, v88, abs(v100)
    v_add_f32_e64 v89, v89, abs(v101)
    v_add_f32_e64 v88, v88, abs(v102)
    v_add_f32_e64 v89, v89, abs(v103)
    s_and_b64 s[64:65], s[64:65], vcc
    v_add_f32 v88, v88, v89
    v_cmp_gt_f32 vcc, 0x7f61b1e6, v88
    s_nop 0
    s_and_b64 s[64:65], s[64:65], vcc
    s_cmp_eq_u64 s[64:65], -1
    s_cbranch_scc1 L_ok_30
    s_mov_b32 s66, s58
    s_add_u32 s65, s66, 8
    v_mov_b32 v80, 0xff61b1e6
    v_mov_b32 v96, 0
    v_mov_b32 v97, 0
    v_mov_b32 v98, 0
    v_mov_b32 v99, 0
    v_mov_b32 v100, 0
    v_mov_b32 v101, 0
    v_mov_b32 v102, 0
    v_mov_b32 v103, 0
    v_mov_b32 v104, 0
    v_mov_b32 v105, 0
    v_mov_b32 v106, 0
    v_mov_b32 v107, 0
    v_mov_b32 v108, 0
    v_mov_b32 v109, 0
    v_mov_b32 v110, 0
    v_mov_b32 v111, 0
    s_lshl_b32 s3, s56, 2
    s_sub_i32 s3, 8, s3
    s_max_i32 s64, s3, s66
L_fb_31:
    s_mul_i32 s3, s64, 4160
    v_add_u32 v81, s3, v176
    v_add_u32 v82, s3, v177
    v_add_u32 v83, s3, v178
    ds_read_b128 v[128:131], v81 offset:0
    ds_read_b128 v[136:139], v82
    ds_read_b128 v[140:143], v83
    s_waitcnt lgkmcnt(0)
    v_mfma_f32_32x32x16_bf16 v[64:79], v[128:131], v[4:7], 0
    s_nop 11
    s_cmp_eq_u32 s64, s65
    s_cbranch_scc0 L_fbd_32
    v_add_f32 v64, v64, v48
    v_add_f32 v65, v65, v49
    v_add_f32 v66, v66, v50
    v_add_f32 v67, v67, v51
    v_add_f32 v68, v68, v52
    v_add_f32 v69, v69, v53
    v_add_f32 v70, v70, v54
    v_add_f32 v71, v71, v55
    v_add_f32 v72, v72, v56
    v_add_f32 v73, v73, v57
    v_add_f32 v74, v74, v58
    v_add_f32 v75, v75, v59
    v_add_f32 v76, v76, v60
    v_add_f32 v77, v77, v61
    v_add_f32 v78, v78, v62
    v_add_f32 v79, v79, v63
L_fbd_32:
    s_cmp_eq_u32 s64, s66
    s_cbranch_scc0 L_fbf_33
    v_add_f32 v64, v64, v16
    v_add_f32 v65, v65, v17
    v_add_f32 v66, v66, v18
    v_add_f32 v67, v67, v19
    v_add_f32 v68, v68, v20
    v_add_f32 v69, v69, v21
    v_add_f32 v70, v70, v22
    v_add_f32 v71, v71, v23
    v_add_f32 v72, v72, v24
    v_add_f32 v73, v73, v25
    v_add_f32 v74, v74, v26
    v_add_f32 v75, v75, v27
    v_add_f32 v76, v76, v28
    v_add_f32 v77, v77, v29
    v_add_f32 v78, v78, v30
    v_add_f32 v79, v79, v31
L_fbf_33:
    v_max3_f32 v80, v64, v65, v80
    v_max3_f32 v80, v66, v67, v80
    v_max3_f32 v80, v68, v69, v80
    v_max3_f32 v80, v70, v71, v80
    v_max3_f32 v80, v72, v73, v80
    v_max3_f32 v80, v74, v75, v80
    v_max3_f32 v80, v76, v77, v80
    v_max3_f32 v80, v78, v79, v80
    s_add_u32 s64, s64, 1
    s_cmp_le_u32 s64, s65
    s_cbranch_scc1 L_fb_31
    v_mov_b32 v81, v80
    s_nop 1
    v_permlane32_swap_b32 v80, v81
    v_max_f32 v80, v80, v81
    s_lshl_b32 s3, s56, 2
    s_sub_i32 s3, 8, s3
    s_max_i32 s64, s3, s66
L_fb_34:
    s_mul_i32 s3, s64, 4160
    v_add_u32 v81, s3, v176
    v_add_u32 v82, s3, v177
    v_add_u32 v83, s3, v178
    ds_read_b128 v[128:131], v81 offset:0
    ds_read_b128 v[136:139], v82
    ds_read_b128 v[140:143], v83
    s_waitcnt lgkmcnt(0)
    v_mfma_f32_32x32x16_bf16 v[64:79], v[128:131], v[4:7], 0
    s_nop 11
    s_cmp_eq_u32 s64, s65
    s_cbranch_scc0 L_fbd_35
    v_add_f32 v64, v64, v48
    v_add_f32 v65, v65, v49
    v_add_f32 v66, v66, v50
    v_add_f32 v67, v67, v51
    v_add_f32 v68, v68, v52
    v_add_f32 v69, v69, v53
    v_add_f32 v70, v70, v54
    v_add_f32 v71, v71, v55
    v_add_f32 v72, v72, v56
    v_add_f32 v73, v73, v57
    v_add_f32 v74, v74, v58
    v_add_f32 v75, v75, v59
    v_add_f32 v76, v76, v60
    v_add_f32 v77, v77, v61
    v_add_f32 v78, v78, v62
    v_add_f32 v79, v79, v63
L_fbd_35:
    s_cmp_eq_u32 s64, s66
    s_cbranch_scc0 L_fbf_36
    v_add_f32 v64, v64, v16
    v_add_f32 v65, v65, v17
    v_add_f32 v66, v66, v18
    v_add_f32 v67, v67, v19
    v_add_f32 v68, v68, v20
    v_add_f32 v69, v69, v21
    v_add_f32 v70, v70, v22
    v_add_f32 v71, v71, v23
    v_add_f32 v72, v72, v24
    v_add_f32 v73, v73, v25
    v_add_f32 v74, v74, v26
    v_add_f32 v75, v75, v27
    v_add_f32 v76, v76, v28
    v_add_f32 v77, v77, v29
    v_add_f32 v78, v78, v30
    v_add_f32 v79, v79, v31
L_fbf_36:
    v_sub_f32 v64, v64, v80
    v_sub_f32 v65, v65, v80
    v_sub_f32 v66, v66, v80
    v_sub_f32 v67, v67, v80
    v_sub_f32 v68, v68, v80
    v_sub_f32 v69, v69, v80
    v_sub_f32 v70, v70, v80
    v_sub_f32 v71, v71, v80
    v_sub_f32 v72, v72, v80
    v_sub_f32 v73, v73, v80
    v_sub_f32 v74, v74, v80
    v_sub_f32 v75, v75, v80
    v_sub_f32 v76, v76, v80
    v_sub_f32 v77, v77, v80
    v_sub_f32 v78, v78, v80
    v_sub_f32 v79, v79, v80
    v_exp_f32 v64, v64
    v_exp_f32 v65, v65
    v_exp_f32 v66, v66
    v_exp_f32 v67, v67
    v_exp_f32 v68, v68
    v_exp_f32 v69, v69
    v_exp_f32 v70, v70
    v_exp_f32 v71, v71
    v_exp_f32 v72, v72
    v_exp_f32 v73, v73
    v_exp_f32 v74, v74
    v_exp_f32 v75, v75
    v_exp_f32 v76, v76
    v_exp_f32 v77, v77
    v_exp_f32 v78, v78
    v_exp_f32 v79, v79
    v_cvt_pk_bf16_f32 v160, v64, v65
    v_cvt_pk_bf16_f32 v161, v66, v67
    v_cvt_pk_bf16_f32 v162, v68, v69
    v_cvt_pk_bf16_f32 v163, v70, v71
    v_cvt_pk_bf16_f32 v164, v72, v73
    v_cvt_pk_bf16_f32 v165, v74, v75
    v_cvt_pk_bf16_f32 v166, v76, v77
    v_cvt_pk_bf16_f32 v167, v78, v79
    v_mfma_f32_32x32x16_bf16 v[96:111], v[136:139], v[160:163], v[96:111]
    s_nop 0
    v_mfma_f32_32x32x16_bf16 v[96:111], v[140:143], v[164:167], v[96:111]
    s_add_u32 s64, s64, 1
    s_cmp_le_u32 s64, s65
    s_cbranch_scc1 L_fb_34
    s_nop 11
L_ok_30:
    v_cmp_lt_f32 vcc, 0x21800000, v112
    v_add_f32_e64 v88, abs(v120), abs(v121)
    v_add_f32_e64 v89, abs(v122), abs(v123)
    s_mov_b64 s[64:65], vcc
    v_cmp_gt_f32 vcc, 0x5d800000, v112
    v_add_f32_e64 v88, v88, abs(v124)
    v_add_f32_e64 v89, v89, abs(v125)
    v_add_f32_e64 v88, v88, abs(v126)
    v_add_f32_e64 v89, v89, abs(v127)
    s_and_b64 s[64:65], s[64:65], vcc
    v_add_f32 v88, v88, v89
    v_cmp_gt_f32 vcc, 0x7f61b1e6, v88
    s_nop 0
    s_and_b64 s[64:65], s[64:65], vcc
    s_cmp_eq_u64 s[64:65], -1
    s_cbranch_scc1 L_ok_37
    s_sub_u32 s66, 3, s58
    s_add_u32 s65, s66, 8
    v_mov_b32 v80, 0xff61b1e6
    v_mov_b32 v112, 0
    v_mov_b32 v113, 0
    v_mov_b32 v114, 0
    v_mov_b32 v115, 0
    v_mov_b32 v116, 0
    v_mov_b32 v117, 0
    v_mov_b32 v118, 0
    v_mov_b32 v119, 0
    v_mov_b32 v120, 0
    v_mov_b32 v121, 0
    v_mov_b32 v122, 0
    v_mov_b32 v123, 0
    v_mov_b32 v124, 0
    v_mov_b32 v125, 0
    v_mov_b32 v126, 0
    v_mov_b32 v127, 0
    s_lshl_b32 s3, s56, 2
    s_sub_i32 s3, 8, s3
    s_max_i32 s64, s3, s66
L_fb_38:
    s_mul_i32 s3, s64, 4160
    v_add_u32 v81, s3, v176
    v_add_u32 v82, s3, v179
    v_add_u32 v83, s3, v180
    ds_read_b128 v[128:131], v81 offset:1024
    ds_read_b128 v[136:139], v82
    ds_read_b128 v[140:143], v83
    s_waitcnt lgkmcnt(0)
    v_mfma_f32_32x32x16_bf16 v[64:79], v[128:131], v[8:11], 0
    s_nop 11
    s_cmp_eq_u32 s64, s65
    s_cbranch_scc0 L_fbd_39
    v_add_f32 v64, v64, v48
    v_add_f32 v65, v65, v49
    v_add_f32 v66, v66, v50
    v_add_f32 v67, v67, v51
    v_add_f32 v68, v68, v52
    v_add_f32 v69, v69, v53
    v_add_f32 v70, v70, v54
    v_add_f32 v71, v71, v55
    v_add_f32 v72, v72, v56
    v_add_f32 v73, v73, v57
    v_add_f32 v74, v74, v58
    v_add_f32 v75, v75, v59
    v_add_f32 v76, v76, v60
    v_add_f32 v77, v77, v61
    v_add_f32 v78, v78, v62
    v_add_f32 v79, v79, v63
L_fbd_39:
    s_cmp_eq_u32 s64, s66
    s_cbranch_scc0 L_fbf_40
    v_add_f32 v64, v64, v16
    v_add_f32 v65, v65, v17
    v_add_f32 v66, v66, v18
    v_add_f32 v67, v67, v19
    v_add_f32 v68, v68, v20
    v_add_f32 v69, v69, v21
    v_add_f32 v70, v70, v22
    v_add_f32 v71, v71, v23
    v_add_f32 v72, v72, v24
    v_add_f32 v73, v73, v25
    v_add_f32 v74, v74, v26
    v_add_f32 v75, v75, v27
    v_add_f32 v76, v76, v28
    v_add_f32 v77, v77, v29
    v_add_f32 v78, v78, v30
    v_add_f32 v79, v79, v31
L_fbf_40:
    v_max3_f32 v80, v64, v65, v80
    v_max3_f32 v80, v66, v67, v80
    v_max3_f32 v80, v68, v69, v80
    v_max3_f32 v80, v70, v71, v80
    v_max3_f32 v80, v72, v73, v80
    v_max3_f32 v80, v74, v75, v80
    v_max3_f32 v80, v76, v77, v80
    v_max3_f32 v80, v78, v79, v80
    s_add_u32 s64, s64, 1
    s_cmp_le_u32 s64, s65
    s_cbranch_scc1 L_fb_38
    v_mov_b32 v81, v80
    s_nop 1
    v_permlane32_swap_b32 v80, v81
    v_max_f32 v80, v80, v81
    s_lshl_b32 s3, s56, 2
    s_sub_i32 s3, 8, s3
    s_max_i32 s64, s3, s66
L_fb_41:
    s_mul_i32 s3, s64, 4160
    v_add_u32 v81, s3, v176
    v_add_u32 v82, s3, v179
    v_add_u32 v83, s3, v180
    ds_read_b128 v[128:131], v81 offset:1024
    ds_read_b128 v[136:139], v82
    ds_read_b128 v[140:143], v83
    s_waitcnt lgkmcnt(0)
    v_mfma_f32_32x32x16_bf16 v[64:79], v[128:131], v[8:11], 0
    s_nop 11
    s_cmp_eq_u32 s64, s65
    s_cbranch_scc0 L_fbd_42
    v_add_f32 v64, v64, v48
    v_add_f32 v65, v65, v49
    v_add_f32 v66, v66, v50
    v_add_f32 v67, v67, v51
    v_add_f32 v68, v68, v52
    v_add_f32 v69, v69, v53
    v_add_f32 v70, v70, v54
    v_add_f32 v71, v71, v55
    v_add_f32 v72, v72, v56
    v_add_f32 v73, v73, v57
    v_add_f32 v74, v74, v58
    v_add_f32 v75, v75, v59
    v_add_f32 v76, v76, v60
    v_add_f32 v77, v77, v61
    v_add_f32 v78, v78, v62
    v_add_f32 v79, v79, v63
L_fbd_42:
    s_cmp_eq_u32 s64, s66
    s_cbranch_scc0 L_fbf_43
    v_add_f32 v64, v64, v16
    v_add_f32 v65, v65, v17
    v_add_f32 v66, v66, v18
    v_add_f32 v67, v67, v19
    v_add_f32 v68, v68, v20
    v_add_f32 v69, v69, v21
    v_add_f32 v70, v70, v22
    v_add_f32 v71, v71, v23
    v_add_f32 v72, v72, v24
    v_add_f32 v73, v73, v25
    v_add_f32 v74, v74, v26
    v_add_f32 v75, v75, v27
    v_add_f32 v76, v76, v28
    v_add_f32 v77, v77, v29
    v_add_f32 v78, v78, v30
    v_add_f32 v79, v79, v31
L_fbf_43:
    v_sub_f32 v64, v64, v80
    v_sub_f32 v65, v65, v80
    v_sub_f32 v66, v66, v80
    v_sub_f32 v67, v67, v80
    v_sub_f32 v68, v68, v80
    v_sub_f32 v69, v69, v80
    v_sub_f32 v70, v70, v80
    v_sub_f32 v71, v71, v80
    v_sub_f32 v72, v72, v80
    v_sub_f32 v73, v73, v80
    v_sub_f32 v74, v74, v80
    v_sub_f32 v75, v75, v80
    v_sub_f32 v76, v76, v80
    v_sub_f32 v77, v77, v80
    v_sub_f32 v78, v78, v80
    v_sub_f32 v79, v79, v80
    v_exp_f32 v64, v64
    v_exp_f32 v65, v65
    v_exp_f32 v66, v66
    v_exp_f32 v67, v67
    v_exp_f32 v68, v68
    v_exp_f32 v69, v69
    v_exp_f32 v70, v70
    v_exp_f32 v71, v71
    v_exp_f32 v72, v72
    v_exp_f32 v73, v73
    v_exp_f32 v74, v74
    v_exp_f32 v75, v75
    v_exp_f32 v76, v76
    v_exp_f32 v77, v77
    v_exp_f32 v78, v78
    v_exp_f32 v79, v79
    v_cvt_pk_bf16_f32 v160, v64, v65
    v_cvt_pk_bf16_f32 v161, v66, v67
    v_cvt_pk_bf16_f32 v162, v68, v69
    v_cvt_pk_bf16_f32 v163, v70, v71
    v_cvt_pk_bf16_f32 v164, v72, v73
    v_cvt_pk_bf16_f32 v165, v74, v75
    v_cvt_pk_bf16_f32 v166, v76, v77
    v_cvt_pk_bf16_f32 v167, v78, v79
    v_mfma_f32_32x32x16_bf16 v[112:127], v[136:139], v[160:163], v[112:127]
    s_nop 0
    v_mfma_f32_32x32x16_bf16 v[112:127], v[140:143], v[164:167], v[112:127]
    s_add_u32 s64, s64, 1
    s_cmp_le_u32 s64, s65
    s_cbranch_scc1 L_fb_41
    s_nop 11
L_ok_37:
    v_rcp_f32 v105, v104
    v_rcp_f32 v113, v112
    v_accvgpr_read_b32 v13, a243
    v_mul_f32 v96, v96, v105
    v_mul_f32 v97, v97, v105
    v_mul_f32 v98, v98, v105
    v_mul_f32 v99, v99, v105
    v_mul_f32 v100, v100, v105
    v_mul_f32 v101, v101, v105
    v_mul_f32 v102, v102, v105
    v_mul_f32 v103, v103, v105
    v_cvt_pk_bf16_f32 v64, v96, v97
    v_cvt_pk_bf16_f32 v65, v98, v99
    v_cvt_pk_bf16_f32 v66, v100, v101
    v_cvt_pk_bf16_f32 v67, v102, v103
    v_mul_f32 v120, v120, v113
    v_mul_f32 v121, v121, v113
    v_mul_f32 v122, v122, v113
    v_mul_f32 v123, v123, v113
    v_mul_f32 v124, v124, v113
    v_mul_f32 v125, v125, v113
    v_mul_f32 v126, v126, v113
    v_mul_f32 v127, v127, v113
    v_cvt_pk_bf16_f32 v68, v120, v121
    v_cvt_pk_bf16_f32 v69, v122, v123
    v_cvt_pk_bf16_f32 v70, v124, v125
    v_cvt_pk_bf16_f32 v71, v126, v127
    s_cmp_lg_u32 s60, 0
    s_cbranch_scc0 L_slow_44
    buffer_store_dwordx4 v[64:67], v1, s[48:51], s16 offen
    buffer_store_dwordx4 v[68:71], v1, s[48:51], s17 offen
    s_branch L_stored_45
L_slow_44:
    buffer_store_dwordx4 v[64:67], v1, s[48:51], s16 offen sc1
    buffer_store_dwordx4 v[68:71], v1, s[48:51], s17 offen sc1
L_stored_45:
    s_waitcnt vmcnt(2)
    v_and_b32 v236, 31, v12
    v_lshrrev_b32 v237, 5, v12
    v_lshlrev_b32 v4, 6, v236
    v_lshl_add_u32 v4, v237, 3, v4
    s_lshl_b32 s3, s58, 11
    s_add_u32 s3, s3, 154624
    v_add_u32 v4, s3, v4
    ds_read_b64 v[208:209], v4 offset:0
    ds_read_b64 v[210:211], v4 offset:16
    s_mul_i32 s3, s58, 12288
    s_add_u32 s3, s3, 98304
    v_add_u32 v7, s3, v1
    s_xor_b32 s3, s58, 2
    s_mul_i32 s3, s3, 12288
    s_add_u32 s3, s3, 102400
    v_add_u32 v9, s3, v1
    s_xor_b32 s3, s58, 3
    s_mul_i32 s3, s3, 12288
    s_add_u32 s3, s3, 106496
    v_add_u32 v10, s3, v1
    s_xor_b32 s3, s58, 1
    s_mul_i32 s3, s3, 12288
    s_add_u32 s3, s3, 98304
    v_add_u32 v8, s3, v1
    v_lshlrev_b32 v228, 4, v236
    v_lshl_add_u32 v228, v237, 2, v228
    v_lshlrev_b32 v3, 4, v237
    s_lshl_b32 s3, s58, 9
    s_add_u32 s3, s3, 152576
    v_add_u32 v228, s3, v228
    v_add_u32 v3, s3, v3
    s_mov_b32 vcc_lo, 0x00ff0000
    s_mov_b32 vcc_hi, 0x00ff0000
    v_cndmask_b32_e64 v229, 0, 1.0, vcc
    v_add_f32 v212, v212, v216
    v_add_f32 v213, v213, v217
    v_add_f32 v214, v214, v218
    v_add_f32 v215, v215, v219
    v_add_f32 v212, v212, v220
    v_add_f32 v213, v213, v221
    v_add_f32 v214, v214, v222
    v_add_f32 v215, v215, v223
    v_add_f32 v212, v212, v224
    v_add_f32 v213, v213, v225
    v_add_f32 v214, v214, v226
    v_add_f32 v215, v215, v227
    s_waitcnt lgkmcnt(0)
    v_lshlrev_b32 v16, 16, v208
    v_and_b32 v17, s26, v208
    v_lshlrev_b32 v18, 16, v209
    v_and_b32 v19, s26, v209
    v_lshlrev_b32 v20, 16, v210
    v_and_b32 v21, s26, v210
    v_lshlrev_b32 v22, 16, v211
    v_and_b32 v23, s26, v211
    ds_read_b64 v[208:209], v4 offset:32
    ds_read_b64 v[210:211], v4 offset:48
    v_permlane32_swap_b32 v212, v213
    s_waitcnt vmcnt(0)
    s_cmp_lg_u32 s60, 0
    s_cbranch_scc0 L_slow_46
    s_mov_b64 exec, 3
    buffer_store_dword v14, v13, s[48:51], 0 offen
    s_mov_b64 exec, -1
    s_branch L_stored_47
L_slow_46:
    s_mov_b64 exec, 3
    buffer_store_dword v14, v13, s[48:51], 0 offen sc1
    s_mov_b64 exec, -1
L_stored_47:
    v_and_b32 v13, 7, v12
    v_lshlrev_b32 v13, 2, v13
    v_and_b32 v15, 8, v12
    v_lshl_add_u32 v13, v15, 4, v13
    s_lshl_b32 s3, s92, 8
    v_lshl_add_u32 v240, v12, 7, s3
    v_min_u32 v240, (L_code_end-L_g3-4), v240
    s_getpc_b64 s[54:55]
L_pc_48:
    s_add_u32 s54, s54, (L_g3-L_pc_48)
    s_addc_u32 s55, s55, 0
    v_mov_b32 v241, s55
    v_add_co_u32 v240, vcc, s54, v240
    s_nop 1
    v_addc_co_u32 v241, vcc, 0, v241, vcc
    s_mov_b32 m0, 162816
    s_mov_b64 exec, 3
    global_load_lds_dword v[240:241], off
    s_mov_b64 exec, -1
L_poll_49:
    buffer_load_dword v15, v13, s[48:51], s38 offen sc1
    s_waitcnt vmcnt(0)
    v_cmp_ne_u32 vcc, s59, v15
    s_cbranch_vccz L_polled_50
    s_cmp_eq_u32 s61, 0
    s_cbranch_scc1 L_polled_50
    s_sub_u32 s61, s61, 1
    s_branch L_poll_49
L_polled_50:
    buffer_load_dwordx4 v[128:131], v1, s[48:51], s36 offen sc1
    buffer_load_dwordx4 v[132:135], v1, s[48:51], s36 offen offset:1024 sc1
    s_barrier
    buffer_load_dwordx4 v[136:139], v1, s[48:51], s36 offen offset:2048 sc1
    buffer_load_dwordx4 v[140:143], v1, s[48:51], s36 offen offset:3072 sc1
    s_waitcnt vmcnt(3)
    v_mfma_f32_32x32x16_bf16 v[64:79], a[0:3], v[128:131], 0
    s_add_u32 s36, s36, 4096
    buffer_load_dwordx4 v[144:147], v1, s[48:51], s36 offen sc1
    v_permlane32_swap_b32 v214, v215
    v_add_f32 v212, v212, v213
    v_add_f32 v214, v214, v215
    v_cvt_pk_bf16_f32 v212, v212, v212
    v_mfma_f32_32x32x16_bf16 v[80:95], a[32:35], v[128:131], 0
    buffer_load_dwordx4 v[148:151], v1, s[48:51], s36 offen offset:1024 sc1
    v_cvt_pk_bf16_f32 v214, v214, v214
    v_and_b32 v212, s26, v212
    v_and_b32 v214, s26, v214
    v_add_f32 v212, v212, v229
    s_waitcnt vmcnt(4)
    v_mfma_f32_32x32x16_bf16 v[64:79], a[4:7], v[132:135], v[64:79]
    buffer_load_dwordx4 v[152:155], v1, s[48:51], s36 offen offset:2048 sc1
    v_add_f32 v214, v214, v229
    v_cvt_pk_bf16_f32 v212, v212, v212
    v_cvt_pk_bf16_f32 v214, v214, v214
    v_and_b32 v212, s26, v212
    v_mfma_f32_32x32x16_bf16 v[80:95], a[36:39], v[132:135], v[80:95]
    buffer_load_dwordx4 v[156:159], v1, s[48:51], s36 offen offset:3072 sc1
    v_and_b32 v214, s26, v214
    ds_write_b32 v228, v212
    ds_write_b32 v228, v214 offset:8
    ds_read_b128 v[96:99], v3 offset:0
    s_waitcnt vmcnt(5)
    v_mfma_f32_32x32x16_bf16 v[64:79], a[8:11], v[136:139], v[64:79]
    buffer_load_dwordx4 v[160:163], v1, s[48:51], s37 offen sc1
    ds_read_b128 v[100:103], v3 offset:32
    ds_read_b128 v[104:107], v3 offset:64
    ds_read_b128 v[108:111], v3 offset:96
    ds_read_b128 v[112:115], v3 offset:128
    v_mfma_f32_32x32x16_bf16 v[80:95], a[40:43], v[136:139], v[80:95]
    buffer_load_dwordx4 v[164:167], v1, s[48:51], s37 offen offset:1024 sc1
    ds_read_b128 v[116:119], v3 offset:160
    ds_read_b128 v[120:123], v3 offset:192
    ds_read_b128 v[124:127], v3 offset:224
    ds_read_b128 v[192:195], v3 offset:256
    s_waitcnt vmcnt(6)
    v_mfma_f32_32x32x16_bf16 v[64:79], a[12:15], v[140:143], v[64:79]
    buffer_load_dwordx4 v[168:171], v1, s[48:51], s37 offen offset:2048 sc1
    ds_read_b128 v[196:199], v3 offset:288
    ds_read_b128 v[200:203], v3 offset:320
    ds_read_b128 v[204:207], v3 offset:352
    s_waitcnt lgkmcnt(0)
    v_mfma_f32_32x32x16_bf16 v[80:95], a[44:47], v[140:143], v[80:95]
    buffer_load_dwordx4 v[172:175], v1, s[48:51], s37 offen offset:3072 sc1
    v_lshlrev_b32 v24, 16, v208
    v_and_b32 v25, s26, v208
    v_lshlrev_b32 v26, 16, v209
    v_and_b32 v27, s26, v209
    s_waitcnt vmcnt(7)
    v_mfma_f32_32x32x16_bf16 v[64:79], a[16:19], v[144:147], v[64:79]
    s_add_u32 s37, s37, 4096
    buffer_load_dwordx4 v[176:179], v1, s[48:51], s37 offen sc1
    v_lshlrev_b32 v28, 16, v210
    v_and_b32 v29, s26, v210
    v_lshlrev_b32 v30, 16, v211
    v_and_b32 v31, s26, v211
    v_mfma_f32_32x32x16_bf16 v[80:95], a[48:51], v[144:147], v[80:95]
    v_lshlrev_b32 v216, 2, v12
    s_lshl_b32 s3, s58, 8
    s_add_u32 s3, s3, 148224
    v_add_u32 v217, s3, v216
    s_xor_b32 s3, s58, 1
    s_lshl_b32 s3, s3, 8
    s_add_u32 s3, s3, 148224
    v_add_u32 v216, s3, v216
    s_waitcnt vmcnt(7)
    v_mfma_f32_32x32x16_bf16 v[64:79], a[20:23], v[148:151], v[64:79]
    buffer_load_dwordx4 v[180:183], v1, s[48:51], s37 offen offset:1024 sc1
    v_mfma_f32_32x32x16_bf16 v[80:95], a[52:55], v[148:151], v[80:95]
    s_waitcnt vmcnt(7)
    v_mfma_f32_32x32x16_bf16 v[64:79], a[24:27], v[152:155], v[64:79]
    buffer_load_dwordx4 v[184:187], v1, s[48:51], s37 offen offset:2048 sc1
    v_mfma_f32_32x32x16_bf16 v[80:95], a[56:59], v[152:155], v[80:95]
    s_waitcnt vmcnt(7)
    v_mfma_f32_32x32x16_bf16 v[64:79], a[28:31], v[156:159], v[64:79]
    buffer_load_dwordx4 v[188:191], v1, s[48:51], s37 offen offset:3072 sc1
    v_mfma_f32_32x32x16_bf16 v[80:95], a[60:63], v[156:159], v[80:95]
    s_waitcnt vmcnt(7)
    v_mfma_f32_32x32x16_bf16 v[48:63], a[32:35], v[160:163], 0
    s_add_u32 s89, s22, 6
    s_and_b32 s89, s89, 7
    s_mul_i32 s89, s89, 176128
    s_add_u32 s89, s89, s85
    s_add_u32 m0, s86, 73728
    s_nop 0
    buffer_load_dwordx4 v232, s[12:15], s89 offen lds
    v_mfma_f32_32x32x16_bf16 v[32:47], a[0:3], v[160:163], 0
    ds_write_b128 v9, v[64:67] offset:0
    ds_write_b128 v9, v[68:71] offset:1024
    ds_write_b128 v9, v[72:75] offset:2048
    s_waitcnt vmcnt(7)
    v_mfma_f32_32x32x16_bf16 v[48:63], a[36:39], v[164:167], v[48:63]
    s_add_u32 m0, s86, 74752
    s_nop 0
    buffer_load_dwordx4 v233, s[12:15], s89 offen lds
    ds_write_b128 v9, v[76:79] offset:3072
    ds_write_b128 v10, v[80:83] offset:0
    ds_write_b128 v10, v[84:87] offset:1024
    v_mfma_f32_32x32x16_bf16 v[32:47], a[4:7], v[164:167], v[32:47]
    ds_write_b128 v10, v[88:91] offset:2048
    ds_write_b128 v10, v[92:95] offset:3072
    s_waitcnt lgkmcnt(0)
    s_barrier
    s_waitcnt vmcnt(7)
    v_mfma_f32_32x32x16_bf16 v[48:63], a[40:43], v[168:171], v[48:63]
    s_add_u32 m0, s86, 75776
    s_nop 0
    buffer_load_dwordx4 v234, s[12:15], s89 offen lds
    ds_read_b128 v[64:67], v7 offset:4096
    ds_read_b128 v[68:71], v7 offset:5120
    ds_read_b128 v[72:75], v7 offset:6144
    v_mfma_f32_32x32x16_bf16 v[32:47], a[8:11], v[168:171], v[32:47]
    ds_read_b128 v[76:79], v7 offset:7168
    ds_read_b128 v[80:83], v7 offset:8192
    ds_read_b128 v[84:87], v7 offset:9216
    s_waitcnt vmcnt(7)
    v_mfma_f32_32x32x16_bf16 v[48:63], a[44:47], v[172:175], v[48:63]
    s_add_u32 s89, s22, 7
    s_and_b32 s89, s89, 7
    s_mul_i32 s89, s89, 176128
    s_add_u32 s89, s89, s85
    s_add_u32 m0, s86, 86016
    s_nop 0
    buffer_load_dwordx4 v232, s[12:15], s89 offen lds
    ds_read_b128 v[88:91], v7 offset:10240
    ds_read_b128 v[92:95], v7 offset:11264
    v_mfma_f32_32x32x16_bf16 v[32:47], a[12:15], v[172:175], v[32:47]
    s_waitcnt lgkmcnt(0)
    s_waitcnt vmcnt(7)
    v_mfma_f32_32x32x16_bf16 v[48:63], a[48:51], v[176:179], v[48:63]
    s_add_u32 m0, s86, 87040
    s_nop 0
    buffer_load_dwordx4 v233, s[12:15], s89 offen lds
    v_pk_add_f32 v[64:65], v[64:65], v[80:81]
    v_pk_add_f32 v[66:67], v[66:67], v[82:83]
    v_pk_add_f32 v[68:69], v[68:69], v[84:85]
    s_waitcnt vmcnt(7)
    v_mfma_f32_32x32x16_bf16 v[48:63], a[52:55], v[180:183], v[48:63]
    v_pk_add_f32 v[70:71], v[70:71], v[86:87]
    v_pk_add_f32 v[72:73], v[72:73], v[88:89]
    v_pk_add_f32 v[74:75], v[74:75], v[90:91]
    s_waitcnt vmcnt(6)
    v_mfma_f32_32x32x16_bf16 v[48:63], a[56:59], v[184:187], v[48:63]
    s_add_u32 m0, s86, 88064
    s_nop 0
    buffer_load_dwordx4 v234, s[12:15], s89 offen lds
    v_pk_add_f32 v[76:77], v[76:77], v[92:93]
    v_pk_add_f32 v[78:79], v[78:79], v[94:95]
    s_waitcnt vmcnt(6)
    v_mfma_f32_32x32x16_bf16 v[48:63], a[60:63], v[188:191], v[48:63]
    v_mfma_f32_32x32x16_bf16 v[32:47], a[16:19], v[176:179], v[32:47]
    v_mfma_f32_32x32x16_bf16 v[32:47], a[20:23], v[180:183], v[32:47]
    s_nop 9
    ds_write_b128 v8, v[48:51] offset:0
    ds_write_b128 v8, v[52:55] offset:1024
    v_mfma_f32_32x32x16_bf16 v[32:47], a[24:27], v[184:187], v[32:47]
    ds_write_b128 v8, v[56:59] offset:2048
    v_mfma_f32_32x32x16_bf16 v[32:47], a[28:31], v[188:191], v[32:47]
    ds_write_b128 v8, v[60:63] offset:3072
    buffer_load_dwordx4 a[156:159], v1, s[48:51], s91 offen offset:1024 sc1
    buffer_load_dwordx4 a[72:75], v1, s[48:51], s84 offen offset:2048 sc1
    buffer_load_dwordx4 a[160:163], v1, s[48:51], s91 offen offset:2048 sc1
    buffer_load_dwordx4 a[76:79], v1, s[48:51], s84 offen offset:3072 sc1
    s_waitcnt lgkmcnt(0)
    s_barrier
    ds_read_b128 v[48:51], v7 offset:0
    ds_read_b128 v[52:55], v7 offset:1024
    ds_read_b128 v[56:59], v7 offset:2048
    ds_read_b128 v[60:63], v7 offset:3072
    s_nop 0
    v_pk_add_f32 v[32:33], v[32:33], v[64:65]
    v_pk_add_f32 v[34:35], v[34:35], v[66:67]
    v_pk_add_f32 v[36:37], v[36:37], v[68:69]
    v_pk_add_f32 v[38:39], v[38:39], v[70:71]
    v_pk_add_f32 v[40:41], v[40:41], v[72:73]
    v_pk_add_f32 v[42:43], v[42:43], v[74:75]
    v_pk_add_f32 v[44:45], v[44:45], v[76:77]
    v_pk_add_f32 v[46:47], v[46:47], v[78:79]
    s_waitcnt lgkmcnt(0)
    v_pk_add_f32 v[32:33], v[32:33], v[48:49]
    v_pk_add_f32 v[34:35], v[34:35], v[50:51]
    v_pk_add_f32 v[36:37], v[36:37], v[52:53]
    v_pk_add_f32 v[38:39], v[38:39], v[54:55]
    v_pk_add_f32 v[40:41], v[40:41], v[56:57]
    v_pk_add_f32 v[42:43], v[42:43], v[58:59]
    v_pk_add_f32 v[44:45], v[44:45], v[60:61]
    v_pk_add_f32 v[46:47], v[46:47], v[62:63]
    s_mov_b32 s64, 0x3f803f80
    v_fmac_f32 v16, v96, v32
    v_fmac_f32 v17, v97, v33
    v_fmac_f32 v18, v98, v34
    v_fmac_f32 v19, v99, v35
    v_fmac_f32 v20, v100, v36
    v_fmac_f32 v21, v101, v37
    v_fmac_f32 v22, v102, v38
    v_fmac_f32 v23, v103, v39
    v_fmac_f32 v24, v104, v40
    v_fmac_f32 v25, v105, v41
    v_fmac_f32 v26, v106, v42
    v_fmac_f32 v27, v107, v43
    v_fmac_f32 v28, v108, v44
    v_fmac_f32 v29, v109, v45
    v_fmac_f32 v30, v110, v46
    v_fmac_f32 v31, v111, v47
    v_cvt_pk_bf16_f32 v80, v16, v17
    v_cvt_pk_bf16_f32 v81, v18, v19
    v_cvt_pk_bf16_f32 v82, v20, v21
    v_cvt_pk_bf16_f32 v83, v22, v23
    v_cvt_pk_bf16_f32 v84, v24, v25
    v_cvt_pk_bf16_f32 v85, v26, v27
    v_cvt_pk_bf16_f32 v86, v28, v29
    v_cvt_pk_bf16_f32 v87, v30, v31
    v_dot2_f32_bf16 v88, v80, s64, 0
    v_dot2_f32_bf16 v90, v80, v80, 0
    v_dot2_f32_bf16 v88, v81, s64, v88
    v_dot2_f32_bf16 v90, v81, v81, v90
    v_dot2_f32_bf16 v88, v82, s64, v88
    v_dot2_f32_bf16 v90, v82, v82, v90
    v_dot2_f32_bf16 v88, v83, s64, v88
    v_dot2_f32_bf16 v90, v83, v83, v90
    v_dot2_f32_bf16 v88, v84, s64, v88
    v_dot2_f32_bf16 v90, v84, v84, v90
    v_dot2_f32_bf16 v88, v85, s64, v88
    v_dot2_f32_bf16 v90, v85, v85, v90
    v_dot2_f32_bf16 v88, v86, s64, v88
    v_dot2_f32_bf16 v90, v86, v86, v90
    v_dot2_f32_bf16 v88, v87, s64, v88
    v_dot2_f32_bf16 v90, v87, v87, v90
    v_mov_b32 v89, s59
    s_nop 1
    v_permlane32_swap_b32 v88, v90
    v_add_f32 v88, v88, v90
    ds_write_b32 v217, v88
    v_lshlrev_b32 v16, 16, v80
    v_and_b32 v17, s26, v80
    v_lshlrev_b32 v18, 16, v81
    v_and_b32 v19, s26, v81
    v_lshlrev_b32 v20, 16, v82
    v_and_b32 v21, s26, v82
    v_lshlrev_b32 v22, 16, v83
    v_and_b32 v23, s26, v83
    s_waitcnt lgkmcnt(0)
    s_barrier
    ds_read_b32 v90, v216
    v_lshlrev_b32 v24, 16, v84
    v_and_b32 v25, s26, v84
    v_lshlrev_b32 v26, 16, v85
    v_and_b32 v27, s26, v85
    v_lshlrev_b32 v28, 16, v86
    v_and_b32 v29, s26, v86
    v_lshlrev_b32 v30, 16, v87
    v_and_b32 v31, s26, v87
    s_waitcnt lgkmcnt(0)
    v_add_f32 v88, v88, v90
    s_cmp_lg_u32 s60, 0
    s_cbranch_scc0 L_slow_51
    buffer_store_dwordx2 v[88:89], v1, s[48:51], s20 offen
    s_branch L_stored_52
L_slow_51:
    buffer_store_dwordx2 v[88:89], v1, s[48:51], s20 offen sc1
L_stored_52:
L_poll_53:
    buffer_load_dwordx4 v[128:131], v1, s[48:51], s6 offen sc1
    buffer_load_dwordx4 v[132:135], v1, s[48:51], s6 offen offset:1024 sc1
    buffer_load_dwordx4 v[136:139], v1, s[48:51], s6 offen offset:2048 sc1
    buffer_load_dwordx4 v[140:143], v1, s[48:51], s6 offen offset:3072 sc1
    s_waitcnt vmcnt(0)
    v_xor_b32 v15, s59, v129
    v_bitop3_b32 v15, v15, v131, s59 bitop3:0xf6
    v_bitop3_b32 v15, v15, v133, s59 bitop3:0xf6
    v_bitop3_b32 v15, v15, v135, s59 bitop3:0xf6
    v_bitop3_b32 v15, v15, v137, s59 bitop3:0xf6
    v_bitop3_b32 v15, v15, v139, s59 bitop3:0xf6
    v_bitop3_b32 v15, v15, v141, s59 bitop3:0xf6
    v_bitop3_b32 v15, v15, v143, s59 bitop3:0xf6
    v_cmp_ne_u32 vcc, 0, v15
    s_cbranch_vccz L_polled_54
    s_cmp_eq_u32 s61, 0
    s_cbranch_scc1 L_polled_54
    s_sub_u32 s61, s61, 1
    s_branch L_poll_53
L_polled_54:
    v_add_f32 v128, v128, v136
    v_add_f32 v130, v130, v138
    v_add_f32 v132, v132, v140
    v_add_f32 v134, v134, v142
    v_add_f32 v128, v128, v132
    v_add_f32 v130, v130, v134
    v_add_f32 v128, v128, v130
    v_mov_b32 v130, v128
    s_nop 1
    v_permlane32_swap_b32 v128, v130
    v_mul_f32 v128, 0x3b000000, v128
    v_mul_f32 v129, v128, v128
    s_mov_b32 s75, 0x3b000000
    v_fma_f32 v130, v130, s75, -v129
    v_max_f32 v130, 0, v130
    v_cvt_pk_bf16_f32 v128, v128, v128
    v_and_b32 v128, s26, v128
    v_cvt_pk_bf16_f32 v130, v130, v130
    v_and_b32 v130, s26, v130
    v_add_f32 v130, 0x3727c5ac, v130
    v_cvt_pk_bf16_f32 v130, v130, v130
    v_and_b32 v130, s26, v130
    v_sqrt_f32 v130, v130
    s_nop 0
    v_cvt_pk_bf16_f32 v130, v130, v130
    v_and_b32 v130, s26, v130
    v_rcp_f32 v130, v130
    s_nop 0
    v_mul_f32 v128, v128, v130
    s_waitcnt lgkmcnt(0)
    v_fma_f32 v80, v16, v130, -v128
    v_fma_f32 v81, v17, v130, -v128
    v_fma_f32 v82, v18, v130, -v128
    v_fma_f32 v83, v19, v130, -v128
    v_fma_f32 v84, v20, v130, -v128
    v_fma_f32 v85, v21, v130, -v128
    v_fma_f32 v86, v22, v130, -v128
    v_fma_f32 v87, v23, v130, -v128
    v_fma_f32 v88, v24, v130, -v128
    v_fma_f32 v89, v25, v130, -v128
    v_fma_f32 v90, v26, v130, -v128
    v_fma_f32 v91, v27, v130, -v128
    v_fma_f32 v92, v28, v130, -v128
    v_fma_f32 v93, v29, v130, -v128
    v_fma_f32 v94, v30, v130, -v128
    v_fma_f32 v95, v31, v130, -v128
    v_fma_f32 v80, v80, v192, v112
    v_fma_f32 v81, v81, v193, v113
    v_fma_f32 v82, v82, v194, v114
    v_fma_f32 v83, v83, v195, v115
    v_fma_f32 v84, v84, v196, v116
    v_fma_f32 v85, v85, v197, v117
    v_fma_f32 v86, v86, v198, v118
    v_fma_f32 v87, v87, v199, v119
    v_fma_f32 v88, v88, v200, v120
    v_fma_f32 v89, v89, v201, v121
    v_fma_f32 v90, v90, v202, v122
    v_fma_f32 v91, v91, v203, v123
    v_fma_f32 v92, v92, v204, v124
    v_fma_f32 v93, v93, v205, v125
    v_fma_f32 v94, v94, v206, v126
    v_fma_f32 v95, v95, v207, v127
    v_cvt_pk_bf16_f32 v64, v80, v81
    v_cvt_pk_bf16_f32 v65, v82, v83
    v_cvt_pk_bf16_f32 v66, v84, v85
    v_cvt_pk_bf16_f32 v67, v86, v87
    v_cvt_pk_bf16_f32 v68, v88, v89
    v_cvt_pk_bf16_f32 v69, v90, v91
    v_cvt_pk_bf16_f32 v70, v92, v93
    v_cvt_pk_bf16_f32 v71, v94, v95
    v_mov_b32 v13, 0
    s_cmp_lg_u32 s60, 0
    s_cbranch_scc0 L_slow_55
    buffer_store_dwordx4 v[64:67], v1, s[8:11], s4 offen
    buffer_store_dwordx4 v[68:71], v1, s[8:11], s4 offen offset:1024
    s_branch L_stored_56
L_slow_55:
    buffer_store_dwordx4 v[64:67], v1, s[8:11], s4 offen sc1
    buffer_store_dwordx4 v[68:71], v1, s[8:11], s4 offen offset:1024 sc1
L_stored_56:
    s_waitcnt vmcnt(0)
    s_cmp_lg_u32 s60, 0
    s_cbranch_scc0 L_slow_57
    s_mov_b64 exec, 1
    buffer_store_dword v14, v13, s[48:51], s5 offen
    s_mov_b64 exec, -1
    s_branch L_stored_58
L_slow_57:
    s_mov_b64 exec, 1
    buffer_store_dword v14, v13, s[48:51], s5 offen sc1
    s_mov_b64 exec, -1
L_stored_58:
L_g3:
    v_and_b32 v13, 15, v12
    v_lshlrev_b32 v13, 2, v13
    v_mov_b32 v5, v255
    v_add_u32 v6, 0xc000, v5
    s_lshl_b32 s65, s27, 15
    s_mov_b32 s72, 0xbfb8aa3b
    s_mov_b32 s73, 0xbfb8aa3b
    s_add_u32 s67, s88, 4096
    s_cmp_ge_u32 s57, 11
    s_cselect_b32 s67, 0x7f000000, s67
    s_barrier
    ds_read_b64_tr_b16 v[32:33], v5 offset:0
    ds_read_b64_tr_b16 v[34:35], v5 offset:1536
    ds_read_b64_tr_b16 v[36:37], v5 offset:64
    ds_read_b64_tr_b16 v[38:39], v5 offset:1600
    ds_read_b64_tr_b16 v[40:41], v5 offset:128
    ds_read_b64_tr_b16 v[42:43], v5 offset:1664
    ds_read_b64_tr_b16 v[44:45], v5 offset:3072
    ds_read_b64_tr_b16 v[46:47], v5 offset:4608
    ds_read_b64_tr_b16 v[48:49], v5 offset:3136
    ds_read_b64_tr_b16 v[50:51], v5 offset:4672
    ds_read_b64_tr_b16 v[52:53], v5 offset:3200
    ds_read_b64_tr_b16 v[54:55], v5 offset:4736
L_poll_59:
    buffer_load_dword v15, v13, s[48:51], s39 offen sc1
    s_waitcnt vmcnt(0)
    v_cmp_ne_u32 vcc, s59, v15
    s_cbranch_vccz L_polled_60
    s_cmp_eq_u32 s61, 0
    s_cbranch_scc1 L_polled_60
    s_sub_u32 s61, s61, 1
    s_branch L_poll_59
L_polled_60:
    s_add_u32 s7, s22, 0
    s_and_b32 s7, s7, 7
    s_lshl_b32 s7, s7, 12
    s_add_u32 s7, s7, s65
    buffer_load_dwordx4 v[128:131], v1, s[8:11], s7 offen sc1
    buffer_load_dwordx4 v[132:135], v1, s[8:11], s7 offen offset:1024 sc1
    buffer_load_dwordx4 v[136:139], v1, s[8:11], s7 offen offset:2048 sc1
    buffer_load_dwordx4 v[140:143], v1, s[8:11], s7 offen offset:3072 sc1
    s_add_u32 s7, s22, 1
    s_and_b32 s7, s7, 7
    s_lshl_b32 s7, s7, 12
    s_add_u32 s7, s7, s65
    buffer_load_dwordx4 v[144:147], v1, s[8:11], s7 offen sc1
    buffer_load_dwordx4 v[148:151], v1, s[8:11], s7 offen offset:1024 sc1
    buffer_load_dwordx4 v[152:155], v1, s[8:11], s7 offen offset:2048 sc1
    buffer_load_dwordx4 v[156:159], v1, s[8:11], s7 offen offset:3072 sc1
    s_waitcnt vmcnt(7) lgkmcnt(8)
    v_mfma_f32_32x32x16_bf16 v[64:79], v[32:35], v[128:131], 0
    s_add_u32 s7, s22, 2
    s_and_b32 s7, s7, 7
    s_lshl_b32 s7, s7, 12
    s_add_u32 s7, s7, s65
    buffer_load_dwordx4 v[160:163], v1, s[8:11], s7 offen sc1
    ds_read_b64_tr_b16 v[56:57], v5 offset:6144
    ds_read_b64_tr_b16 v[58:59], v5 offset:7680
    v_mfma_f32_32x32x16_bf16 v[80:95], v[36:39], v[128:131], 0
    ds_read_b64_tr_b16 v[60:61], v5 offset:6208
    ds_read_b64_tr_b16 v[62:63], v5 offset:7744
    s_waitcnt lgkmcnt(8)
    v_mfma_f32_32x32x16_bf16 v[96:111], v[40:43], v[128:131], 0
    buffer_load_dwordx4 v[164:167], v1, s[8:11], s7 offen offset:1024 sc1
    ds_read_b64_tr_b16 v[32:33], v5 offset:6272
    ds_read_b64_tr_b16 v[34:35], v5 offset:7808
    s_waitcnt vmcnt(8)
    v_mfma_f32_32x32x16_bf16 v[64:79], v[44:47], v[132:135], v[64:79]
    ds_read_b64_tr_b16 v[36:37], v5 offset:9216
    ds_read_b64_tr_b16 v[38:39], v5 offset:10752
    s_waitcnt lgkmcnt(8)
    v_mfma_f32_32x32x16_bf16 v[80:95], v[48:51], v[132:135], v[80:95]
    buffer_load_dwordx4 v[168:171], v1, s[8:11], s7 offen offset:2048 sc1
    ds_read_b64_tr_b16 v[40:41], v5 offset:9280
    ds_read_b64_tr_b16 v[42:43], v5 offset:10816
    v_mfma_f32_32x32x16_bf16 v[96:111], v[52:55], v[132:135], v[96:111]
    ds_read_b64_tr_b16 v[44:45], v5 offset:9344
    ds_read_b64_tr_b16 v[46:47], v5 offset:10880
    s_waitcnt vmcnt(8) lgkmcnt(8)
    v_mfma_f32_32x32x16_bf16 v[64:79], v[56:59], v[136:139], v[64:79]
    buffer_load_dwordx4 v[172:175], v1, s[8:11], s7 offen offset:3072 sc1
    ds_read_b64_tr_b16 v[48:49], v5 offset:12288
    ds_read_b64_tr_b16 v[50:51], v5 offset:13824
    v_mfma_f32_32x32x16_bf16 v[80:95], v[60:63], v[136:139], v[80:95]
    ds_read_b64_tr_b16 v[52:53], v5 offset:12352
    ds_read_b64_tr_b16 v[54:55], v5 offset:13888
    s_waitcnt lgkmcnt(8)
    v_mfma_f32_32x32x16_bf16 v[96:111], v[32:35], v[136:139], v[96:111]
    s_add_u32 s7, s22, 3
    s_and_b32 s7, s7, 7
    s_lshl_b32 s7, s7, 12
    s_add_u32 s7, s7, s65
    buffer_load_dwordx4 v[176:179], v1, s[8:11], s7 offen sc1
    ds_read_b64_tr_b16 v[56:57], v5 offset:12416
    ds_read_b64_tr_b16 v[58:59], v5 offset:13952
    s_waitcnt vmcnt(9)
    v_mfma_f32_32x32x16_bf16 v[64:79], v[36:39], v[140:143], v[64:79]
    ds_read_b64_tr_b16 v[60:61], v5 offset:15360
    ds_read_b64_tr_b16 v[62:63], v5 offset:16896
    s_waitcnt lgkmcnt(8)
    v_mfma_f32_32x32x16_bf16 v[80:95], v[40:43], v[140:143], v[80:95]
    buffer_load_dwordx4 v[180:183], v1, s[8:11], s7 offen offset:1024 sc1
    ds_read_b64_tr_b16 v[32:33], v5 offset:15424
    ds_read_b64_tr_b16 v[34:35], v5 offset:16960
    v_mfma_f32_32x32x16_bf16 v[96:111], v[44:47], v[140:143], v[96:111]
    ds_read_b64_tr_b16 v[36:37], v5 offset:15488
    ds_read_b64_tr_b16 v[38:39], v5 offset:17024
    s_waitcnt vmcnt(9) lgkmcnt(8)
    v_mfma_f32_32x32x16_bf16 v[64:79], v[48:51], v[144:147], v[64:79]
    buffer_load_dwordx4 v[184:187], v1, s[8:11], s7 offen offset:2048 sc1
    ds_read_b64_tr_b16 v[40:41], v5 offset:18432
    ds_read_b64_tr_b16 v[42:43], v5 offset:19968
    v_mfma_f32_32x32x16_bf16 v[80:95], v[52:55], v[144:147], v[80:95]
    ds_read_b64_tr_b16 v[44:45], v5 offset:18496
    ds_read_b64_tr_b16 v[46:47], v5 offset:20032
    s_waitcnt lgkmcnt(8)
    v_mfma_f32_32x32x16_bf16 v[96:111], v[56:59], v[144:147], v[96:111]
    buffer_load_dwordx4 v[188:191], v1, s[8:11], s7 offen offset:3072 sc1
    ds_read_b64_tr_b16 v[48:49], v5 offset:18560
    ds_read_b64_tr_b16 v[50:51], v5 offset:20096
    s_waitcnt vmcnt(10)
    v_mfma_f32_32x32x16_bf16 v[64:79], v[60:63], v[148:151], v[64:79]
    ds_read_b64_tr_b16 v[52:53], v5 offset:21504
    ds_read_b64_tr_b16 v[54:55], v5 offset:23040
    s_waitcnt lgkmcnt(8)
    v_mfma_f32_32x32x16_bf16 v[80:95], v[32:35], v[148:151], v[80:95]
    s_add_u32 s7, s22, 4
    s_and_b32 s7, s7, 7
    s_lshl_b32 s7, s7, 12
    s_add_u32 s7, s7, s65
    buffer_load_dwordx4 v[192:195], v1, s[8:11], s7 offen sc1
    ds_read_b64_tr_b16 v[56:57], v5 offset:21568
    ds_read_b64_tr_b16 v[58:59], v5 offset:23104
    v_mfma_f32_32x32x16_bf16 v[96:111], v[36:39], v[148:151], v[96:111]
    ds_read_b64_tr_b16 v[60:61], v5 offset:21632
    ds_read_b64_tr_b16 v[62:63], v5 offset:23168
    s_waitcnt vmcnt(10) lgkmcnt(8)
    v_mfma_f32_32x32x16_bf16 v[64:79], v[40:43], v[152:155], v[64:79]
    buffer_load_dwordx4 v[196:199], v1, s[8:11], s7 offen offset:1024 sc1
    ds_read_b64_tr_b16 v[32:33], v5 offset:24576
    ds_read_b64_tr_b16 v[34:35], v5 offset:26112
    v_mfma_f32_32x32x16_bf16 v[80:95], v[44:47], v[152:155], v[80:95]
    ds_read_b64_tr_b16 v[36:37], v5 offset:24640
    ds_read_b64_tr_b16 v[38:39], v5 offset:26176
    s_waitcnt lgkmcnt(8)
    v_mfma_f32_32x32x16_bf16 v[96:111], v[48:51], v[152:155], v[96:111]
    buffer_load_dwordx4 v[200:203], v1, s[8:11], s7 offen offset:2048 sc1
    ds_read_b64_tr_b16 v[40:41], v5 offset:24704
    ds_read_b64_tr_b16 v[42:43], v5 offset:26240
    s_waitcnt vmcnt(11)
    v_mfma_f32_32x32x16_bf16 v[64:79], v[52:55], v[156:159], v[64:79]
    ds_read_b64_tr_b16 v[44:45], v5 offset:27648
    ds_read_b64_tr_b16 v[46:47], v5 offset:29184
    s_waitcnt lgkmcnt(8)
    v_mfma_f32_32x32x16_bf16 v[80:95], v[56:59], v[156:159], v[80:95]
    buffer_load_dwordx4 v[204:207], v1, s[8:11], s7 offen offset:3072 sc1
    ds_read_b64_tr_b16 v[48:49], v5 offset:27712
    ds_read_b64_tr_b16 v[50:51], v5 offset:29248
    v_mfma_f32_32x32x16_bf16 v[96:111], v[60:63], v[156:159], v[96:111]
    ds_read_b64_tr_b16 v[52:53], v5 offset:27776
    ds_read_b64_tr_b16 v[54:55], v5 offset:29312
    s_waitcnt vmcnt(11) lgkmcnt(8)
    v_mfma_f32_32x32x16_bf16 v[64:79], v[32:35], v[160:163], v[64:79]
    s_add_u32 s7, s22, 5
    s_and_b32 s7, s7, 7
    s_lshl_b32 s7, s7, 12
    s_add_u32 s7, s7, s65
    buffer_load_dwordx4 v[208:211], v1, s[8:11], s7 offen sc1
    ds_read_b64_tr_b16 v[56:57], v5 offset:30720
    ds_read_b64_tr_b16 v[58:59], v5 offset:32256
    v_mfma_f32_32x32x16_bf16 v[80:95], v[36:39], v[160:163], v[80:95]
    ds_read_b64_tr_b16 v[60:61], v5 offset:30784
    ds_read_b64_tr_b16 v[62:63], v5 offset:32320
    s_waitcnt lgkmcnt(8)
    v_mfma_f32_32x32x16_bf16 v[96:111], v[40:43], v[160:163], v[96:111]
    buffer_load_dwordx4 v[212:215], v1, s[8:11], s7 offen offset:1024 sc1
    ds_read_b64_tr_b16 v[32:33], v5 offset:30848
    ds_read_b64_tr_b16 v[34:35], v5 offset:32384
    s_waitcnt vmcnt(12)
    v_mfma_f32_32x32x16_bf16 v[64:79], v[44:47], v[164:167], v[64:79]
    ds_read_b64_tr_b16 v[36:37], v5 offset:33792
    ds_read_b64_tr_b16 v[38:39], v5 offset:35328
    s_waitcnt lgkmcnt(8)
    v_mfma_f32_32x32x16_bf16 v[80:95], v[48:51], v[164:167], v[80:95]
    buffer_load_dwordx4 v[216:219], v1, s[8:11], s7 offen offset:2048 sc1
    ds_read_b64_tr_b16 v[40:41], v5 offset:33856
    ds_read_b64_tr_b16 v[42:43], v5 offset:35392
    v_mfma_f32_32x32x16_bf16 v[96:111], v[52:55], v[164:167], v[96:111]
    ds_read_b64_tr_b16 v[44:45], v5 offset:33920
    ds_read_b64_tr_b16 v[46:47], v5 offset:35456
    s_waitcnt vmcnt(12) lgkmcnt(8)
    v_mfma_f32_32x32x16_bf16 v[64:79], v[56:59], v[168:171], v[64:79]
    buffer_load_dwordx4 v[220:223], v1, s[8:11], s7 offen offset:3072 sc1
    ds_read_b64_tr_b16 v[48:49], v5 offset:36864
    ds_read_b64_tr_b16 v[50:51], v5 offset:38400
    v_mfma_f32_32x32x16_bf16 v[80:95], v[60:63], v[168:171], v[80:95]
    ds_read_b64_tr_b16 v[52:53], v5 offset:36928
    ds_read_b64_tr_b16 v[54:55], v5 offset:38464
    s_waitcnt lgkmcnt(8)
    v_mfma_f32_32x32x16_bf16 v[96:111], v[32:35], v[168:171], v[96:111]
    s_add_u32 s7, s22, 6
    s_and_b32 s7, s7, 7
    s_lshl_b32 s7, s7, 12
    s_add_u32 s7, s7, s65
    buffer_load_dwordx4 v[224:227], v1, s[8:11], s7 offen sc1
    ds_read_b64_tr_b16 v[56:57], v5 offset:36992
    ds_read_b64_tr_b16 v[58:59], v5 offset:38528
    s_waitcnt vmcnt(13)
    v_mfma_f32_32x32x16_bf16 v[64:79], v[36:39], v[172:175], v[64:79]
    ds_read_b64_tr_b16 v[60:61], v5 offset:39936
    ds_read_b64_tr_b16 v[62:63], v5 offset:41472
    s_waitcnt lgkmcnt(8)
    v_mfma_f32_32x32x16_bf16 v[80:95], v[40:43], v[172:175], v[80:95]
    buffer_load_dwordx4 v[228:231], v1, s[8:11], s7 offen offset:1024 sc1
    ds_read_b64_tr_b16 v[32:33], v5 offset:40000
    ds_read_b64_tr_b16 v[34:35], v5 offset:41536
    v_mfma_f32_32x32x16_bf16 v[96:111], v[44:47], v[172:175], v[96:111]
    ds_read_b64_tr_b16 v[36:37], v5 offset:40064
    ds_read_b64_tr_b16 v[38:39], v5 offset:41600
    s_waitcnt vmcnt(13) lgkmcnt(8)
    v_mfma_f32_32x32x16_bf16 v[64:79], v[48:51], v[176:179], v[64:79]
    buffer_load_dwordx4 v[232:235], v1, s[8:11], s7 offen offset:2048 sc1
    ds_read_b64_tr_b16 v[40:41], v5 offset:43008
    ds_read_b64_tr_b16 v[42:43], v5 offset:44544
    v_mfma_f32_32x32x16_bf16 v[80:95], v[52:55], v[176:179], v[80:95]
    ds_read_b64_tr_b16 v[44:45], v5 offset:43072
    ds_read_b64_tr_b16 v[46:47], v5 offset:44608
    s_waitcnt lgkmcnt(8)
    v_mfma_f32_32x32x16_bf16 v[96:111], v[56:59], v[176:179], v[96:111]
    buffer_load_dwordx4 v[236:239], v1, s[8:11], s7 offen offset:3072 sc1
    ds_read_b64_tr_b16 v[48:49], v5 offset:43136
    ds_read_b64_tr_b16 v[50:51], v5 offset:44672
    s_waitcnt vmcnt(14)
    v_mfma_f32_32x32x16_bf16 v[64:79], v[60:63], v[180:183], v[64:79]
    ds_read_b64_tr_b16 v[52:53], v5 offset:46080
    ds_read_b64_tr_b16 v[54:55], v5 offset:47616
    s_waitcnt lgkmcnt(8)
    v_mfma_f32_32x32x16_bf16 v[80:95], v[32:35], v[180:183], v[80:95]
    s_add_u32 s7, s22, 7
    s_and_b32 s7, s7, 7
    s_lshl_b32 s7, s7, 12
    s_add_u32 s7, s7, s65
    buffer_load_dwordx4 v[240:243], v1, s[8:11], s7 offen sc1
    ds_read_b64_tr_b16 v[56:57], v5 offset:46144
    ds_read_b64_tr_b16 v[58:59], v5 offset:47680
    v_mfma_f32_32x32x16_bf16 v[96:111], v[36:39], v[180:183], v[96:111]
    ds_read_b64_tr_b16 v[60:61], v5 offset:46208
    ds_read_b64_tr_b16 v[62:63], v5 offset:47744
    s_waitcnt vmcnt(14) lgkmcnt(8)
    v_mfma_f32_32x32x16_bf16 v[64:79], v[40:43], v[184:187], v[64:79]
    buffer_load_dwordx4 v[244:247], v1, s[8:11], s7 offen offset:1024 sc1
    ds_read_b64_tr_b16 v[32:33], v6 offset:0
    ds_read_b64_tr_b16 v[34:35], v6 offset:1536
    v_mfma_f32_32x32x16_bf16 v[80:95], v[44:47], v[184:187], v[80:95]
    ds_read_b64_tr_b16 v[36:37], v6 offset:64
    ds_read_b64_tr_b16 v[38:39], v6 offset:1600
    s_waitcnt lgkmcnt(8)
    v_mfma_f32_32x32x16_bf16 v[96:111], v[48:51], v[184:187], v[96:111]
    buffer_load_dwordx4 v[248:251], v1, s[8:11], s7 offen offset:2048 sc1
    ds_read_b64_tr_b16 v[40:41], v6 offset:128
    ds_read_b64_tr_b16 v[42:43], v6 offset:1664
    s_waitcnt vmcnt(15)
    v_mfma_f32_32x32x16_bf16 v[64:79], v[52:55], v[188:191], v[64:79]
    ds_read_b64_tr_b16 v[44:45], v6 offset:3072
    ds_read_b64_tr_b16 v[46:47], v6 offset:4608
    s_waitcnt lgkmcnt(8)
    v_mfma_f32_32x32x16_bf16 v[80:95], v[56:59], v[188:191], v[80:95]
    buffer_load_dwordx4 v[252:255], v1, s[8:11], s7 offen offset:3072 sc1
    ds_read_b64_tr_b16 v[48:49], v6 offset:3136
    ds_read_b64_tr_b16 v[50:51], v6 offset:4672
    v_mfma_f32_32x32x16_bf16 v[96:111], v[60:63], v[188:191], v[96:111]
    ds_read_b64_tr_b16 v[52:53], v6 offset:3200
    ds_read_b64_tr_b16 v[54:55], v6 offset:4736
    s_waitcnt vmcnt(15) lgkmcnt(8)
    v_mfma_f32_32x32x16_bf16 v[64:79], v[32:35], v[192:195], v[64:79]
    v_accvgpr_read_b32 v11, a249
    buffer_load_dword v15, v11, s[48:51], s88 offen sc1
    ds_read_b64_tr_b16 v[56:57], v6 offset:6144
    ds_read_b64_tr_b16 v[58:59], v6 offset:7680
    v_mfma_f32_32x32x16_bf16 v[80:95], v[36:39], v[192:195], v[80:95]
    ds_read_b64_tr_b16 v[60:61], v6 offset:6208
    ds_read_b64_tr_b16 v[62:63], v6 offset:7744
    s_waitcnt lgkmcnt(8)
    v_mfma_f32_32x32x16_bf16 v[96:111], v[40:43], v[192:195], v[96:111]
    buffer_load_dwordx4 a[164:167], v1, s[48:51], s91 offen offset:3072 sc1
    ds_read_b64_tr_b16 v[32:33], v6 offset:6272
    ds_read_b64_tr_b16 v[34:35], v6 offset:7808
    s_waitcnt vmcnt(16)
    v_mfma_f32_32x32x16_bf16 v[64:79], v[44:47], v[196:199], v[64:79]
    ds_read_b64_tr_b16 v[36:37], v6 offset:9216
    ds_read_b64_tr_b16 v[38:39], v6 offset:10752
    s_waitcnt lgkmcnt(8)
    v_mfma_f32_32x32x16_bf16 v[80:95], v[48:51], v[196:199], v[80:95]
    s_add_u32 s84, s84, 4096
    buffer_load_dwordx4 a[80:83], v1, s[48:51], s84 offen sc1
    ds_read_b64_tr_b16 v[40:41], v6 offset:9280
    ds_read_b64_tr_b16 v[42:43], v6 offset:10816
    v_mfma_f32_32x32x16_bf16 v[96:111], v[52:55], v[196:199], v[96:111]
    ds_read_b64_tr_b16 v[44:45], v6 offset:9344
    ds_read_b64_tr_b16 v[46:47], v6 offset:10880
    s_waitcnt vmcnt(16) lgkmcnt(8)
    v_mfma_f32_32x32x16_bf16 v[64:79], v[56:59], v[200:203], v[64:79]
    s_add_u32 s91, s91, 4096
    buffer_load_dwordx4 a[168:171], v1, s[48:51], s91 offen sc1
    ds_read_b64_tr_b16 v[48:49], v6 offset:12288
    ds_read_b64_tr_b16 v[50:51], v6 offset:13824
    v_mfma_f32_32x32x16_bf16 v[80:95], v[60:63], v[200:203], v[80:95]
    ds_read_b64_tr_b16 v[52:53], v6 offset:12352
    ds_read_b64_tr_b16 v[54:55], v6 offset:13888
    s_waitcnt lgkmcnt(8)
    v_mfma_f32_32x32x16_bf16 v[96:111], v[32:35], v[200:203], v[96:111]
    buffer_load_dwordx4 a[84:87], v1, s[48:51], s84 offen offset:1024 sc1
    ds_read_b64_tr_b16 v[56:57], v6 offset:12416
    ds_read_b64_tr_b16 v[58:59], v6 offset:13952
    s_waitcnt vmcnt(17)
    v_mfma_f32_32x32x16_bf16 v[64:79], v[36:39], v[204:207], v[64:79]
    ds_read_b64_tr_b16 v[60:61], v6 offset:15360
    ds_read_b64_tr_b16 v[62:63], v6 offset:16896
    s_waitcnt lgkmcnt(8)
    v_mfma_f32_32x32x16_bf16 v[80:95], v[40:43], v[204:207], v[80:95]
    buffer_load_dwordx4 a[172:175], v1, s[48:51], s91 offen offset:1024 sc1
    ds_read_b64_tr_b16 v[32:33], v6 offset:15424
    ds_read_b64_tr_b16 v[34:35], v6 offset:16960
    v_mfma_f32_32x32x16_bf16 v[96:111], v[44:47], v[204:207], v[96:111]
    ds_read_b64_tr_b16 v[36:37], v6 offset:15488
    ds_read_b64_tr_b16 v[38:39], v6 offset:17024
    s_waitcnt vmcnt(17) lgkmcnt(8)
    v_mfma_f32_32x32x16_bf16 v[64:79], v[48:51], v[208:211], v[64:79]
    buffer_load_dwordx4 a[88:91], v1, s[48:51], s84 offen offset:2048 sc1
    ds_read_b64_tr_b16 v[40:41], v6 offset:18432
    ds_read_b64_tr_b16 v[42:43], v6 offset:19968
    v_mfma_f32_32x32x16_bf16 v[80:95], v[52:55], v[208:211], v[80:95]
    ds_read_b64_tr_b16 v[44:45], v6 offset:18496
    ds_read_b64_tr_b16 v[46:47], v6 offset:20032
    s_waitcnt lgkmcnt(8)
    v_mfma_f32_32x32x16_bf16 v[96:111], v[56:59], v[208:211], v[96:111]
    buffer_load_dwordx4 a[176:179], v1, s[48:51], s91 offen offset:2048 sc1
    ds_read_b64_tr_b16 v[48:49], v6 offset:18560
    ds_read_b64_tr_b16 v[50:51], v6 offset:20096
    s_waitcnt vmcnt(18)
    v_mfma_f32_32x32x16_bf16 v[64:79], v[60:63], v[212:215], v[64:79]
    ds_read_b64_tr_b16 v[52:53], v6 offset:21504
    ds_read_b64_tr_b16 v[54:55], v6 offset:23040
    s_waitcnt lgkmcnt(8)
    v_mfma_f32_32x32x16_bf16 v[80:95], v[32:35], v[212:215], v[80:95]
    buffer_load_dwordx4 a[92:95], v1, s[48:51], s84 offen offset:3072 sc1
    ds_read_b64_tr_b16 v[56:57], v6 offset:21568
    ds_read_b64_tr_b16 v[58:59], v6 offset:23104
    v_mfma_f32_32x32x16_bf16 v[96:111], v[36:39], v[212:215], v[96:111]
    ds_read_b64_tr_b16 v[60:61], v6 offset:21632
    ds_read_b64_tr_b16 v[62:63], v6 offset:23168
    s_waitcnt vmcnt(18) lgkmcnt(8)
    v_mfma_f32_32x32x16_bf16 v[64:79], v[40:43], v[216:219], v[64:79]
    buffer_load_dwordx4 a[180:183], v1, s[48:51], s91 offen offset:3072 sc1
    ds_read_b64_tr_b16 v[32:33], v6 offset:24576
    ds_read_b64_tr_b16 v[34:35], v6 offset:26112
    v_mfma_f32_32x32x16_bf16 v[80:95], v[44:47], v[216:219], v[80:95]
    ds_read_b64_tr_b16 v[36:37], v6 offset:24640
    ds_read_b64_tr_b16 v[38:39], v6 offset:26176
    s_waitcnt lgkmcnt(8)
    v_mfma_f32_32x32x16_bf16 v[96:111], v[48:51], v[216:219], v[96:111]
    s_add_u32 s84, s84, 4096
    buffer_load_dwordx4 a[96:99], v1, s[48:51], s84 offen sc1
    ds_read_b64_tr_b16 v[40:41], v6 offset:24704
    ds_read_b64_tr_b16 v[42:43], v6 offset:26240
    s_waitcnt vmcnt(19)
    v_mfma_f32_32x32x16_bf16 v[64:79], v[52:55], v[220:223], v[64:79]
    ds_read_b64_tr_b16 v[44:45], v6 offset:27648
    ds_read_b64_tr_b16 v[46:47], v6 offset:29184
    s_waitcnt lgkmcnt(8)
    v_mfma_f32_32x32x16_bf16 v[80:95], v[56:59], v[220:223], v[80:95]
    s_add_u32 s91, s91, 4096
    buffer_load_dwordx4 a[184:187], v1, s[48:51], s91 offen sc1
    ds_read_b64_tr_b16 v[48:49], v6 offset:27712
    ds_read_b64_tr_b16 v[50:51], v6 offset:29248
    v_mfma_f32_32x32x16_bf16 v[96:111], v[60:63], v[220:223], v[96:111]
    ds_read_b64_tr_b16 v[52:53], v6 offset:27776
    ds_read_b64_tr_b16 v[54:55], v6 offset:29312
    s_waitcnt vmcnt(19) lgkmcnt(8)
    v_mfma_f32_32x32x16_bf16 v[64:79], v[32:35], v[224:227], v[64:79]
    buffer_load_dwordx4 a[100:103], v1, s[48:51], s84 offen offset:1024 sc1
    ds_read_b64_tr_b16 v[56:57], v6 offset:30720
    ds_read_b64_tr_b16 v[58:59], v6 offset:32256
    v_mfma_f32_32x32x16_bf16 v[80:95], v[36:39], v[224:227], v[80:95]
    ds_read_b64_tr_b16 v[60:61], v6 offset:33792
    ds_read_b64_tr_b16 v[62:63], v6 offset:35328
    s_waitcnt lgkmcnt(8)
    v_mfma_f32_32x32x16_bf16 v[96:111], v[40:43], v[224:227], v[96:111]
    buffer_load_dwordx4 a[188:191], v1, s[48:51], s91 offen offset:1024 sc1
    ds_read_b64_tr_b16 v[32:33], v6 offset:36864
    ds_read_b64_tr_b16 v[34:35], v6 offset:38400
    s_waitcnt vmcnt(20)
    v_mfma_f32_32x32x16_bf16 v[64:79], v[44:47], v[228:231], v[64:79]
    ds_read_b64_tr_b16 v[36:37], v6 offset:39936
    ds_read_b64_tr_b16 v[38:39], v6 offset:41472
    s_waitcnt lgkmcnt(8)
    v_mfma_f32_32x32x16_bf16 v[80:95], v[48:51], v[228:231], v[80:95]
    buffer_load_dwordx4 a[104:107], v1, s[48:51], s84 offen offset:2048 sc1
    ds_read_b64_tr_b16 v[40:41], v6 offset:43008
    ds_read_b64_tr_b16 v[42:43], v6 offset:44544
    v_mfma_f32_32x32x16_bf16 v[96:111], v[52:55], v[228:231], v[96:111]
    ds_read_b64_tr_b16 v[44:45], v6 offset:46080
    ds_read_b64_tr_b16 v[46:47], v6 offset:47616
    s_waitcnt vmcnt(20) lgkmcnt(8)
    v_mfma_f32_32x32x16_bf16 v[64:79], v[56:59], v[232:235], v[64:79]
    buffer_load_dwordx4 a[192:195], v1, s[48:51], s91 offen offset:2048 sc1
    ds_read_b64_tr_b16 v[48:49], v6 offset:30784
    ds_read_b64_tr_b16 v[50:51], v6 offset:32320
    s_waitcnt vmcnt(20)
    v_mfma_f32_32x32x16_bf16 v[64:79], v[60:63], v[236:239], v[64:79]
    ds_read_b64_tr_b16 v[52:53], v6 offset:33856
    ds_read_b64_tr_b16 v[54:55], v6 offset:35392
    s_waitcnt vmcnt(19) lgkmcnt(8)
    v_mfma_f32_32x32x16_bf16 v[64:79], v[32:35], v[240:243], v[64:79]
    buffer_load_dwordx4 a[108:111], v1, s[48:51], s84 offen offset:3072 sc1
    ds_read_b64_tr_b16 v[56:57], v6 offset:36928
    ds_read_b64_tr_b16 v[58:59], v6 offset:38464
    s_waitcnt vmcnt(19)
    v_mfma_f32_32x32x16_bf16 v[64:79], v[36:39], v[244:247], v[64:79]
    ds_read_b64_tr_b16 v[60:61], v6 offset:40000
    ds_read_b64_tr_b16 v[62:63], v6 offset:41536
    s_waitcnt vmcnt(18) lgkmcnt(8)
    v_mfma_f32_32x32x16_bf16 v[64:79], v[40:43], v[248:251], v[64:79]
    buffer_load_dwordx4 a[196:199], v1, s[48:51], s91 offen offset:3072 sc1
    ds_read_b64_tr_b16 v[32:33], v6 offset:43072
    ds_read_b64_tr_b16 v[34:35], v6 offset:44608
    s_waitcnt vmcnt(18)
    v_mfma_f32_32x32x16_bf16 v[64:79], v[44:47], v[252:255], v[64:79]
    ds_read_b64_tr_b16 v[36:37], v6 offset:46144
    ds_read_b64_tr_b16 v[38:39], v6 offset:47680
    s_waitcnt lgkmcnt(8)
    v_mfma_f32_32x32x16_bf16 v[80:95], v[48:51], v[232:235], v[80:95]
    s_add_u32 s84, s84, 4096
    buffer_load_dwordx4 a[112:115], v1, s[48:51], s84 offen sc1
    ds_read_b64_tr_b16 v[40:41], v6 offset:30848
    ds_read_b64_tr_b16 v[42:43], v6 offset:32384
    v_mfma_f32_32x32x16_bf16 v[80:95], v[52:55], v[236:239], v[80:95]
    s_nop 2
    v_pk_mul_f32 v[112:113], v[64:65], s[72:73]
    v_pk_mul_f32 v[114:115], v[66:67], s[72:73]
    v_exp_f32 v112, v112
    v_exp_f32 v113, v113
    v_exp_f32 v114, v114
    ds_read_b64_tr_b16 v[44:45], v6 offset:33920
    ds_read_b64_tr_b16 v[46:47], v6 offset:35456
    s_waitcnt lgkmcnt(8)
    v_mfma_f32_32x32x16_bf16 v[80:95], v[56:59], v[240:243], v[80:95]
    s_add_u32 s91, s91, 4096
    buffer_load_dwordx4 a[200:203], v1, s[48:51], s91 offen sc1
    v_exp_f32 v115, v115
    v_pk_add_f32 v[112:113], v[112:113], 1.0 op_sel_hi:[1,0]
    v_pk_add_f32 v[114:115], v[114:115], 1.0 op_sel_hi:[1,0]
    v_rcp_f32 v112, v112
    v_rcp_f32 v113, v113
    ds_read_b64_tr_b16 v[48:49], v6 offset:36992
    ds_read_b64_tr_b16 v[50:51], v6 offset:38528
    v_mfma_f32_32x32x16_bf16 v[80:95], v[60:63], v[244:247], v[80:95]
    v_rcp_f32 v114, v114
    v_rcp_f32 v115, v115
    v_pk_mul_f32 v[64:65], v[64:65], v[112:113]
    v_pk_mul_f32 v[66:67], v[66:67], v[114:115]
    v_cvt_pk_bf16_f32 v116, v64, v65
    ds_read_b64_tr_b16 v[52:53], v6 offset:40064
    ds_read_b64_tr_b16 v[54:55], v6 offset:41600
    s_waitcnt lgkmcnt(8)
    v_mfma_f32_32x32x16_bf16 v[80:95], v[32:35], v[248:251], v[80:95]
    buffer_load_dwordx4 a[116:119], v1, s[48:51], s84 offen offset:1024 sc1
    v_cvt_pk_bf16_f32 v117, v66, v67
    v_pk_mul_f32 v[112:113], v[68:69], s[72:73]
    v_pk_mul_f32 v[114:115], v[70:71], s[72:73]
    v_exp_f32 v112, v112
    v_exp_f32 v113, v113
    ds_read_b64_tr_b16 v[56:57], v6 offset:43136
    ds_read_b64_tr_b16 v[58:59], v6 offset:44672
    v_mfma_f32_32x32x16_bf16 v[80:95], v[36:39], v[252:255], v[80:95]
    v_exp_f32 v114, v114
    v_exp_f32 v115, v115
    v_pk_add_f32 v[112:113], v[112:113], 1.0 op_sel_hi:[1,0]
    v_pk_add_f32 v[114:115], v[114:115], 1.0 op_sel_hi:[1,0]
    v_rcp_f32 v112, v112
    ds_read_b64_tr_b16 v[60:61], v6 offset:46208
    ds_read_b64_tr_b16 v[62:63], v6 offset:47744
    s_waitcnt lgkmcnt(8)
    v_mfma_f32_32x32x16_bf16 v[96:111], v[40:43], v[232:235], v[96:111]
    buffer_load_dwordx4 a[204:207], v1, s[48:51], s91 offen offset:1024 sc1
    v_rcp_f32 v113, v113
    v_rcp_f32 v114, v114
    v_rcp_f32 v115, v115
    v_pk_mul_f32 v[68:69], v[68:69], v[112:113]
    v_pk_mul_f32 v[70:71], v[70:71], v[114:115]
    v_mfma_f32_32x32x16_bf16 v[96:111], v[44:47], v[236:239], v[96:111]
    v_cvt_pk_bf16_f32 v118, v68, v69
    v_cvt_pk_bf16_f32 v119, v70, v71
    s_cmp_lg_u32 s60, 0
    s_cbranch_scc0 L_slow_61
    buffer_store_dwordx4 v[116:119], v1, s[48:51], s88 offen
    s_branch L_stored_62
L_slow_61:
    buffer_store_dwordx4 v[116:119], v1, s[48:51], s88 offen sc1
L_stored_62:
    v_pk_mul_f32 v[112:113], v[72:73], s[72:73]
    v_pk_mul_f32 v[114:115], v[74:75], s[72:73]
    s_waitcnt lgkmcnt(4)
    v_mfma_f32_32x32x16_bf16 v[96:111], v[48:51], v[240:243], v[96:111]
    buffer_load_dwordx4 a[120:123], v1, s[48:51], s84 offen offset:2048 sc1
    v_exp_f32 v112, v112
    v_exp_f32 v113, v113
    v_exp_f32 v114, v114
    v_exp_f32 v115, v115
    v_pk_add_f32 v[112:113], v[112:113], 1.0 op_sel_hi:[1,0]
    v_mfma_f32_32x32x16_bf16 v[96:111], v[52:55], v[244:247], v[96:111]
    v_pk_add_f32 v[114:115], v[114:115], 1.0 op_sel_hi:[1,0]
    v_rcp_f32 v112, v112
    v_rcp_f32 v113, v113
    v_rcp_f32 v114, v114
    v_rcp_f32 v115, v115
    s_waitcnt lgkmcnt(0)
    v_mfma_f32_32x32x16_bf16 v[96:111], v[56:59], v[248:251], v[96:111]
    buffer_load_dwordx4 a[208:211], v1, s[48:51], s91 offen offset:2048 sc1
    v_pk_mul_f32 v[72:73], v[72:73], v[112:113]
    v_pk_mul_f32 v[74:75], v[74:75], v[114:115]
    v_cvt_pk_bf16_f32 v120, v72, v73
    v_cvt_pk_bf16_f32 v121, v74, v75
    v_pk_mul_f32 v[112:113], v[76:77], s[72:73]
    v_mfma_f32_32x32x16_bf16 v[96:111], v[60:63], v[252:255], v[96:111]
    v_pk_mul_f32 v[114:115], v[78:79], s[72:73]
    v_exp_f32 v112, v112
    v_exp_f32 v113, v113
    v_exp_f32 v114, v114
    v_exp_f32 v115, v115
    v_pk_add_f32 v[112:113], v[112:113], 1.0 op_sel_hi:[1,0]
    buffer_load_dwordx4 a[124:127], v1, s[48:51], s84 offen offset:3072 sc1
    v_pk_add_f32 v[114:115], v[114:115], 1.0 op_sel_hi:[1,0]
    v_rcp_f32 v112, v112
    v_rcp_f32 v113, v113
    v_rcp_f32 v114, v114
    v_rcp_f32 v115, v115
    v_pk_mul_f32 v[76:77], v[76:77], v[112:113]
    v_pk_mul_f32 v[78:79], v[78:79], v[114:115]
    v_cvt_pk_bf16_f32 v122, v76, v77
    v_cvt_pk_bf16_f32 v123, v78, v79
    s_cmp_lg_u32 s60, 0
    s_cbranch_scc0 L_slow_63
    buffer_store_dwordx4 v[120:123], v1, s[48:51], s88 offen offset:1024
    s_branch L_stored_64
L_slow_63:
    buffer_store_dwordx4 v[120:123], v1, s[48:51], s88 offen offset:1024 sc1
L_stored_64:
    buffer_load_dwordx4 a[212:215], v1, s[48:51], s91 offen offset:3072 sc1
    v_pk_mul_f32 v[112:113], v[80:81], s[72:73]
    v_pk_mul_f32 v[114:115], v[82:83], s[72:73]
    v_exp_f32 v112, v112
    v_exp_f32 v113, v113
    v_exp_f32 v114, v114
    v_exp_f32 v115, v115
    v_pk_add_f32 v[112:113], v[112:113], 1.0 op_sel_hi:[1,0]
    v_pk_add_f32 v[114:115], v[114:115], 1.0 op_sel_hi:[1,0]
    v_rcp_f32 v112, v112
    v_rcp_f32 v113, v113
    s_add_u32 s84, s84, 4096
    buffer_load_dwordx4 a[128:131], v1, s[48:51], s84 offen sc1
    v_rcp_f32 v114, v114
    v_rcp_f32 v115, v115
    v_pk_mul_f32 v[80:81], v[80:81], v[112:113]
    v_pk_mul_f32 v[82:83], v[82:83], v[114:115]
    v_cvt_pk_bf16_f32 v116, v80, v81
    v_cvt_pk_bf16_f32 v117, v82, v83
    v_pk_mul_f32 v[112:113], v[84:85], s[72:73]
    v_pk_mul_f32 v[114:115], v[86:87], s[72:73]
    v_exp_f32 v112, v112
    v_exp_f32 v113, v113
    s_add_u32 s91, s91, 4096
    buffer_load_dwordx4 a[216:219], v1, s[48:51], s91 offen sc1
    v_exp_f32 v114, v114
    v_exp_f32 v115, v115
    v_pk_add_f32 v[112:113], v[112:113], 1.0 op_sel_hi:[1,0]
    v_pk_add_f32 v[114:115], v[114:115], 1.0 op_sel_hi:[1,0]
    v_rcp_f32 v112, v112
    v_rcp_f32 v113, v113
    v_rcp_f32 v114, v114
    v_rcp_f32 v115, v115
    v_pk_mul_f32 v[84:85], v[84:85], v[112:113]
    v_pk_mul_f32 v[86:87], v[86:87], v[114:115]
    buffer_load_dwordx4 a[132:135], v1, s[48:51], s84 offen offset:1024 sc1
    v_cvt_pk_bf16_f32 v118, v84, v85
    v_cvt_pk_bf16_f32 v119, v86, v87
    s_cmp_lg_u32 s60, 0
    s_cbranch_scc0 L_slow_65
    buffer_store_dwordx4 v[116:119], v1, s[48:51], s88 offen offset:2048
    s_branch L_stored_66
L_slow_65:
    buffer_store_dwordx4 v[116:119], v1, s[48:51], s88 offen offset:2048 sc1
L_stored_66:
    v_pk_mul_f32 v[112:113], v[88:89], s[72:73]
    v_pk_mul_f32 v[114:115], v[90:91], s[72:73]
    v_exp_f32 v112, v112
    v_exp_f32 v113, v113
    v_exp_f32 v114, v114
    v_exp_f32 v115, v115
    v_pk_add_f32 v[112:113], v[112:113], 1.0 op_sel_hi:[1,0]
    buffer_load_dwordx4 a[220:223], v1, s[48:51], s91 offen offset:1024 sc1
    v_pk_add_f32 v[114:115], v[114:115], 1.0 op_sel_hi:[1,0]
    v_rcp_f32 v112, v112
    v_rcp_f32 v113, v113
    v_rcp_f32 v114, v114
    v_rcp_f32 v115, v115
    v_pk_mul_f32 v[88:89], v[88:89], v[112:113]
    v_pk_mul_f32 v[90:91], v[90:91], v[114:115]
    v_cvt_pk_bf16_f32 v120, v88, v89
    v_cvt_pk_bf16_f32 v121, v90, v91
    v_pk_mul_f32 v[112:113], v[92:93], s[72:73]
    buffer_load_dwordx4 a[136:139], v1, s[48:51], s84 offen offset:2048 sc1
    v_pk_mul_f32 v[114:115], v[94:95], s[72:73]
    v_exp_f32 v112, v112
    v_exp_f32 v113, v113
    v_exp_f32 v114, v114
    v_exp_f32 v115, v115
    v_pk_add_f32 v[112:113], v[112:113], 1.0 op_sel_hi:[1,0]
    v_pk_add_f32 v[114:115], v[114:115], 1.0 op_sel_hi:[1,0]
    v_rcp_f32 v112, v112
    v_rcp_f32 v113, v113
    v_rcp_f32 v114, v114
    buffer_load_dwordx4 a[224:227], v1, s[48:51], s91 offen offset:2048 sc1
    v_rcp_f32 v115, v115
    v_pk_mul_f32 v[92:93], v[92:93], v[112:113]
    v_pk_mul_f32 v[94:95], v[94:95], v[114:115]
    v_cvt_pk_bf16_f32 v122, v92, v93
    v_cvt_pk_bf16_f32 v123, v94, v95
    s_cmp_lg_u32 s60, 0
    s_cbranch_scc0 L_slow_67
    buffer_store_dwordx4 v[120:123], v1, s[48:51], s88 offen offset:3072
    s_branch L_stored_68
L_slow_67:
    buffer_store_dwordx4 v[120:123], v1, s[48:51], s88 offen offset:3072 sc1
L_stored_68:
    v_pk_mul_f32 v[112:113], v[96:97], s[72:73]
    v_pk_mul_f32 v[114:115], v[98:99], s[72:73]
    v_exp_f32 v112, v112
    v_exp_f32 v113, v113
    v_exp_f32 v114, v114
    v_exp_f32 v115, v115
    v_pk_add_f32 v[112:113], v[112:113], 1.0 op_sel_hi:[1,0]
    v_pk_add_f32 v[114:115], v[114:115], 1.0 op_sel_hi:[1,0]
    v_rcp_f32 v112, v112
    v_rcp_f32 v113, v113
    v_rcp_f32 v114, v114
    v_rcp_f32 v115, v115
    v_pk_mul_f32 v[96:97], v[96:97], v[112:113]
    v_pk_mul_f32 v[98:99], v[98:99], v[114:115]
    v_cvt_pk_bf16_f32 v116, v96, v97
    v_cvt_pk_bf16_f32 v117, v98, v99
    v_pk_mul_f32 v[112:113], v[100:101], s[72:73]
    v_pk_mul_f32 v[114:115], v[102:103], s[72:73]
    v_exp_f32 v112, v112
    v_exp_f32 v113, v113
    v_exp_f32 v114, v114
    v_exp_f32 v115, v115
    v_pk_add_f32 v[112:113], v[112:113], 1.0 op_sel_hi:[1,0]
    v_pk_add_f32 v[114:115], v[114:115], 1.0 op_sel_hi:[1,0]
    v_rcp_f32 v112, v112
    v_rcp_f32 v113, v113
    v_rcp_f32 v114, v114
    v_rcp_f32 v115, v115
    v_pk_mul_f32 v[100:101], v[100:101], v[112:113]
    v_pk_mul_f32 v[102:103], v[102:103], v[114:115]
    v_cvt_pk_bf16_f32 v118, v100, v101
    v_cvt_pk_bf16_f32 v119, v102, v103
    s_cmp_lg_u32 s60, 0
    s_cbranch_scc0 L_slow_69
    buffer_store_dwordx4 v[116:119], v1, s[48:51], s67 offen
    s_branch L_stored_70
L_slow_69:
    buffer_store_dwordx4 v[116:119], v1, s[48:51], s67 offen sc1
L_stored_70:
    v_pk_mul_f32 v[112:113], v[104:105], s[72:73]
    v_pk_mul_f32 v[114:115], v[106:107], s[72:73]
    v_exp_f32 v112, v112
    v_exp_f32 v113, v113
    v_exp_f32 v114, v114
    v_exp_f32 v115, v115
    v_pk_add_f32 v[112:113], v[112:113], 1.0 op_sel_hi:[1,0]
    v_pk_add_f32 v[114:115], v[114:115], 1.0 op_sel_hi:[1,0]
    v_rcp_f32 v112, v112
    v_rcp_f32 v113, v113
    v_rcp_f32 v114, v114
    v_rcp_f32 v115, v115
    v_pk_mul_f32 v[104:105], v[104:105], v[112:113]
    v_pk_mul_f32 v[106:107], v[106:107], v[114:115]
    v_cvt_pk_bf16_f32 v120, v104, v105
    v_cvt_pk_bf16_f32 v121, v106, v107
    v_pk_mul_f32 v[112:113], v[108:109], s[72:73]
    v_pk_mul_f32 v[114:115], v[110:111], s[72:73]
    v_exp_f32 v112, v112
    v_exp_f32 v113, v113
    v_exp_f32 v114, v114
    v_exp_f32 v115, v115
    v_pk_add_f32 v[112:113], v[112:113], 1.0 op_sel_hi:[1,0]
    v_pk_add_f32 v[114:115], v[114:115], 1.0 op_sel_hi:[1,0]
    v_rcp_f32 v112, v112
    v_rcp_f32 v113, v113
    v_rcp_f32 v114, v114
    v_rcp_f32 v115, v115
    v_pk_mul_f32 v[108:109], v[108:109], v[112:113]
    v_pk_mul_f32 v[110:111], v[110:111], v[114:115]
    v_cvt_pk_bf16_f32 v122, v108, v109
    v_cvt_pk_bf16_f32 v123, v110, v111
    s_cmp_lg_u32 s60, 0
    s_cbranch_scc0 L_slow_71
    buffer_store_dwordx4 v[120:123], v1, s[48:51], s67 offen offset:1024
    s_branch L_stored_72
L_slow_71:
    buffer_store_dwordx4 v[120:123], v1, s[48:51], s67 offen offset:1024 sc1
L_stored_72:
    v_mov_b32 v13, 0
    s_waitcnt vmcnt(0)
    s_cmp_lg_u32 s60, 0
    s_cbranch_scc0 L_slow_73
    s_mov_b64 exec, 1
    buffer_store_dword v14, v13, s[48:51], s43 offen
    s_mov_b64 exec, -1
    s_branch L_stored_74
L_slow_73:
    s_mov_b64 exec, 1
    buffer_store_dword v14, v13, s[48:51], s43 offen sc1
    s_mov_b64 exec, -1
L_stored_74:
    buffer_load_dwordx4 a[140:143], v1, s[48:51], s84 offen offset:3072 sc1
    buffer_load_dwordx4 a[228:231], v1, s[48:51], s91 offen offset:3072 sc1
    s_add_u32 s84, s84, 4096
    s_cmp_eq_u32 s58, 3
    s_cselect_b32 s84, 0x7f000000, s84
    buffer_load_dwordx4 a[144:147], v1, s[48:51], s84 offen sc1
    s_add_u32 s91, s91, 4096
    s_cmp_eq_u32 s58, 3
    s_cselect_b32 s91, 0x7f000000, s91
    buffer_load_dwordx4 a[232:235], v1, s[48:51], s91 offen sc1
    buffer_load_dwordx4 a[148:151], v1, s[48:51], s84 offen offset:1024 sc1
    buffer_load_dwordx4 a[236:239], v1, s[48:51], s91 offen offset:1024 sc1
    s_lshl_b32 s3, s58, 2
    s_sub_u32 s3, s3, 1
    s_max_i32 s3, s3, 0
    v_and_b32 v13, 7, v12
    v_min_u32 v13, 4, v13
    v_add_lshl_u32 v13, v13, s3, 2
    v_and_b32 v15, 8, v12
    v_lshl_add_u32 v13, v15, 3, v13
L_poll_75:
    buffer_load_dword v15, v13, s[48:51], s42 offen sc1
    s_waitcnt vmcnt(0)
    v_cmp_ne_u32 vcc, s59, v15
    s_cbranch_vccz L_polled_76
    s_cmp_eq_u32 s61, 0
    s_cbranch_scc1 L_polled_76
    s_sub_u32 s61, s61, 1
    s_branch L_poll_75
L_polled_76:
    buffer_load_dwordx4 v[96:99], v1, s[48:51], s40 offen sc1
    buffer_load_dwordx4 v[100:103], v1, s[48:51], s40 offen offset:1024 sc1
    buffer_load_dwordx4 v[104:107], v1, s[48:51], s40 offen offset:2048 sc1
    buffer_load_dwordx4 v[108:111], v1, s[48:51], s40 offen offset:3072 sc1
    s_waitcnt vmcnt(3)
    v_mfma_f32_32x32x16_bf16 v[64:79], a[64:67], v[96:99], 0
    s_add_u32 s40, s40, 4096
    buffer_load_dwordx4 v[112:115], v1, s[48:51], s40 offen sc1
    v_lshrrev_b32 v13, 2, v12
    v_and_b32 v14, 48, v1
    v_lshl_add_u32 v13, v13, 10, v14
    s_lshl_b32 s3, s58, 11
    s_add_u32 s3, s3, 154624
    v_add_u32 v14, s3, v1
    v_mfma_f32_32x32x16_bf16 v[80:95], a[152:155], v[96:99], 0
    buffer_load_dwordx4 v[116:119], v1, s[48:51], s40 offen offset:1024 sc1
    s_add_u32 s64, s95, 16384
    s_waitcnt vmcnt(4)
    v_mfma_f32_32x32x16_bf16 v[64:79], a[68:71], v[100:103], v[64:79]
    buffer_load_dwordx4 v[120:123], v1, s[48:51], s40 offen offset:2048 sc1
    v_mfma_f32_32x32x16_bf16 v[80:95], a[156:159], v[100:103], v[80:95]
    buffer_load_dwordx4 v[124:127], v1, s[48:51], s40 offen offset:3072 sc1
    s_waitcnt vmcnt(5)
    v_mfma_f32_32x32x16_bf16 v[64:79], a[72:75], v[104:107], v[64:79]
    s_add_u32 s40, s40, 4096
    buffer_load_dwordx4 v[128:131], v1, s[48:51], s40 offen sc1
    v_mfma_f32_32x32x16_bf16 v[80:95], a[160:163], v[104:107], v[80:95]
    buffer_load_dwordx4 v[132:135], v1, s[48:51], s40 offen offset:1024 sc1
    s_waitcnt vmcnt(6)
    v_mfma_f32_32x32x16_bf16 v[64:79], a[76:79], v[108:111], v[64:79]
    buffer_load_dwordx4 v[136:139], v1, s[48:51], s40 offen offset:2048 sc1
    v_mfma_f32_32x32x16_bf16 v[80:95], a[164:167], v[108:111], v[80:95]
    buffer_load_dwordx4 v[140:143], v1, s[48:51], s40 offen offset:3072 sc1
    s_waitcnt vmcnt(7)
    v_mfma_f32_32x32x16_bf16 v[64:79], a[80:83], v[112:115], v[64:79]
    s_add_u32 s40, s40, 4096
    buffer_load_dwordx4 v[144:147], v1, s[48:51], s40 offen sc1
    v_mfma_f32_32x32x16_bf16 v[80:95], a[168:171], v[112:115], v[80:95]
    s_waitcnt vmcnt(7)
    v_mfma_f32_32x32x16_bf16 v[64:79], a[84:87], v[116:119], v[64:79]
    buffer_load_dwordx4 v[148:151], v1, s[48:51], s40 offen offset:1024 sc1
    v_mfma_f32_32x32x16_bf16 v[80:95], a[172:175], v[116:119], v[80:95]
    s_waitcnt vmcnt(7)
    v_mfma_f32_32x32x16_bf16 v[64:79], a[88:91], v[120:123], v[64:79]
    buffer_load_dwordx4 v[152:155], v1, s[48:51], s40 offen offset:2048 sc1
    v_mfma_f32_32x32x16_bf16 v[80:95], a[176:179], v[120:123], v[80:95]
    s_waitcnt vmcnt(7)
    v_mfma_f32_32x32x16_bf16 v[64:79], a[92:95], v[124:127], v[64:79]
    buffer_load_dwordx4 v[156:159], v1, s[48:51], s40 offen offset:3072 sc1
    v_mfma_f32_32x32x16_bf16 v[80:95], a[180:183], v[124:127], v[80:95]
    s_waitcnt vmcnt(7)
    v_mfma_f32_32x32x16_bf16 v[64:79], a[96:99], v[128:131], v[64:79]
    s_add_u32 s40, s40, 4096
    buffer_load_dwordx4 v[160:163], v1, s[48:51], s40 offen sc1
    v_mfma_f32_32x32x16_bf16 v[80:95], a[184:187], v[128:131], v[80:95]
    s_waitcnt vmcnt(7)
    v_mfma_f32_32x32x16_bf16 v[64:79], a[100:103], v[132:135], v[64:79]
    buffer_load_dwordx4 v[164:167], v1, s[48:51], s40 offen offset:1024 sc1
    v_mfma_f32_32x32x16_bf16 v[80:95], a[188:191], v[132:135], v[80:95]
    s_waitcnt vmcnt(7)
    v_mfma_f32_32x32x16_bf16 v[64:79], a[104:107], v[136:139], v[64:79]
    buffer_load_dwordx4 v[168:171], v1, s[48:51], s40 offen offset:2048 sc1
    v_mfma_f32_32x32x16_bf16 v[80:95], a[192:195], v[136:139], v[80:95]
    s_waitcnt vmcnt(7)
    v_mfma_f32_32x32x16_bf16 v[64:79], a[108:111], v[140:143], v[64:79]
    buffer_load_dwordx4 v[172:175], v1, s[48:51], s40 offen offset:3072 sc1
    v_mfma_f32_32x32x16_bf16 v[80:95], a[196:199], v[140:143], v[80:95]
    s_waitcnt vmcnt(7)
    v_mfma_f32_32x32x16_bf16 v[64:79], a[112:115], v[144:147], v[64:79]
    s_add_u32 s40, s40, 4096
    s_cmp_eq_u32 s58, 3
    s_cselect_b32 s40, 0x7f000000, s40
    buffer_load_dwordx4 v[176:179], v1, s[48:51], s40 offen sc1
    v_mfma_f32_32x32x16_bf16 v[80:95], a[200:203], v[144:147], v[80:95]
    s_waitcnt vmcnt(7)
    v_mfma_f32_32x32x16_bf16 v[64:79], a[116:119], v[148:151], v[64:79]
    buffer_load_dwordx4 v[180:183], v1, s[48:51], s40 offen offset:1024 sc1
    ds_read_b128 v[112:115], v3 offset:384
    ds_read_b128 v[116:119], v3 offset:416
    ds_read_b128 v[120:123], v3 offset:448
    v_mfma_f32_32x32x16_bf16 v[80:95], a[204:207], v[148:151], v[80:95]
    ds_read_b128 v[124:127], v3 offset:480
    s_waitcnt vmcnt(7)
    v_mfma_f32_32x32x16_bf16 v[64:79], a[120:123], v[152:155], v[64:79]
    buffer_load_dwordx4 v[184:187], v1, s[48:51], s41 offen sc1
    v_mfma_f32_32x32x16_bf16 v[80:95], a[208:211], v[152:155], v[80:95]
    s_waitcnt vmcnt(7)
    v_mfma_f32_32x32x16_bf16 v[64:79], a[124:127], v[156:159], v[64:79]
    buffer_load_dwordx4 v[188:191], v1, s[48:51], s41 offen offset:1024 sc1
    v_mfma_f32_32x32x16_bf16 v[80:95], a[212:215], v[156:159], v[80:95]
    s_waitcnt vmcnt(7)
    v_mfma_f32_32x32x16_bf16 v[64:79], a[128:131], v[160:163], v[64:79]
    buffer_load_dwordx4 v[192:195], v1, s[48:51], s41 offen offset:2048 sc1
    v_mfma_f32_32x32x16_bf16 v[80:95], a[216:219], v[160:163], v[80:95]
    s_waitcnt vmcnt(7)
    v_mfma_f32_32x32x16_bf16 v[64:79], a[132:135], v[164:167], v[64:79]
    buffer_load_dwordx4 v[196:199], v1, s[48:51], s41 offen offset:3072 sc1
    v_mfma_f32_32x32x16_bf16 v[80:95], a[220:223], v[164:167], v[80:95]
    s_waitcnt vmcnt(7)
    v_mfma_f32_32x32x16_bf16 v[64:79], a[136:139], v[168:171], v[64:79]
    s_add_u32 s41, s41, 4096
    buffer_load_dwordx4 v[200:203], v1, s[48:51], s41 offen sc1
    v_mfma_f32_32x32x16_bf16 v[80:95], a[224:227], v[168:171], v[80:95]
    s_waitcnt vmcnt(7)
    v_mfma_f32_32x32x16_bf16 v[64:79], a[140:143], v[172:175], v[64:79]
    buffer_load_dwordx4 v[204:207], v1, s[48:51], s41 offen offset:1024 sc1
    v_mfma_f32_32x32x16_bf16 v[80:95], a[228:231], v[172:175], v[80:95]
    s_waitcnt vmcnt(7)
    v_mfma_f32_32x32x16_bf16 v[64:79], a[144:147], v[176:179], v[64:79]
    buffer_load_dwordx4 v[208:211], v1, s[48:51], s41 offen offset:2048 sc1
    v_mfma_f32_32x32x16_bf16 v[80:95], a[232:235], v[176:179], v[80:95]
    s_waitcnt vmcnt(7)
    v_mfma_f32_32x32x16_bf16 v[64:79], a[148:151], v[180:183], v[64:79]
    buffer_load_dwordx4 v[212:215], v1, s[48:51], s41 offen offset:3072 sc1
    v_mfma_f32_32x32x16_bf16 v[80:95], a[236:239], v[180:183], v[80:95]
    s_waitcnt vmcnt(7)
    v_mfma_f32_32x32x16_bf16 v[48:63], a[152:155], v[184:187], 0
    s_add_u32 s41, s41, 4096
    buffer_load_dwordx4 v[216:219], v1, s[48:51], s41 offen sc1
    v_mfma_f32_32x32x16_bf16 v[32:47], a[64:67], v[184:187], 0
    s_nop 4
    ds_write_b128 v9, v[64:67] offset:0
    s_waitcnt vmcnt(7)
    v_mfma_f32_32x32x16_bf16 v[48:63], a[156:159], v[188:191], v[48:63]
    buffer_load_dwordx4 v[220:223], v1, s[48:51], s41 offen offset:1024 sc1
    ds_write_b128 v9, v[68:71] offset:1024
    v_mfma_f32_32x32x16_bf16 v[32:47], a[68:71], v[188:191], v[32:47]
    ds_write_b128 v9, v[72:75] offset:2048
    s_waitcnt vmcnt(7)
    v_mfma_f32_32x32x16_bf16 v[48:63], a[160:163], v[192:195], v[48:63]
    buffer_load_dwordx4 v[224:227], v1, s[48:51], s41 offen offset:2048 sc1
    ds_write_b128 v9, v[76:79] offset:3072
    v_mfma_f32_32x32x16_bf16 v[32:47], a[72:75], v[192:195], v[32:47]
    ds_write_b128 v10, v[80:83] offset:0
    s_waitcnt vmcnt(7)
    v_mfma_f32_32x32x16_bf16 v[48:63], a[164:167], v[196:199], v[48:63]
    buffer_load_dwordx4 v[228:231], v1, s[48:51], s41 offen offset:3072 sc1
    ds_write_b128 v10, v[84:87] offset:1024
    v_mfma_f32_32x32x16_bf16 v[32:47], a[76:79], v[196:199], v[32:47]
    ds_write_b128 v10, v[88:91] offset:2048
    s_waitcnt vmcnt(7)
    v_mfma_f32_32x32x16_bf16 v[48:63], a[168:171], v[200:203], v[48:63]
    s_add_u32 s41, s41, 4096
    buffer_load_dwordx4 v[232:235], v1, s[48:51], s41 offen sc1
    ds_write_b128 v10, v[92:95] offset:3072
    v_mfma_f32_32x32x16_bf16 v[32:47], a[80:83], v[200:203], v[32:47]
    s_waitcnt lgkmcnt(0)
    s_barrier
    s_waitcnt vmcnt(7)
    v_mfma_f32_32x32x16_bf16 v[48:63], a[172:175], v[204:207], v[48:63]
    buffer_load_dwordx4 v[236:239], v1, s[48:51], s41 offen offset:1024 sc1
    ds_read_b128 v[64:67], v7 offset:4096
    v_mfma_f32_32x32x16_bf16 v[32:47], a[84:87], v[204:207], v[32:47]
    ds_read_b128 v[68:71], v7 offset:5120
    s_waitcnt vmcnt(7)
    v_mfma_f32_32x32x16_bf16 v[48:63], a[176:179], v[208:211], v[48:63]
    buffer_load_dwordx4 v[240:243], v1, s[48:51], s41 offen offset:2048 sc1
    ds_read_b128 v[72:75], v7 offset:6144
    v_mfma_f32_32x32x16_bf16 v[32:47], a[88:91], v[208:211], v[32:47]
    ds_read_b128 v[76:79], v7 offset:7168
    s_waitcnt vmcnt(7)
    v_mfma_f32_32x32x16_bf16 v[48:63], a[180:183], v[212:215], v[48:63]
    buffer_load_dwordx4 v[244:247], v1, s[48:51], s41 offen offset:3072 sc1
    ds_read_b128 v[80:83], v7 offset:8192
    v_mfma_f32_32x32x16_bf16 v[32:47], a[92:95], v[212:215], v[32:47]
    ds_read_b128 v[84:87], v7 offset:9216
    s_waitcnt vmcnt(7)
    v_mfma_f32_32x32x16_bf16 v[48:63], a[184:187], v[216:219], v[48:63]
    s_add_u32 s41, s41, 4096
    buffer_load_dwordx4 v[248:251], v1, s[48:51], s41 offen sc1
    ds_read_b128 v[88:91], v7 offset:10240
    v_mfma_f32_32x32x16_bf16 v[32:47], a[96:99], v[216:219], v[32:47]
    ds_read_b128 v[92:95], v7 offset:11264
    s_waitcnt vmcnt(7)
    v_mfma_f32_32x32x16_bf16 v[48:63], a[188:191], v[220:223], v[48:63]
    buffer_load_dwordx4 v[252:255], v1, s[48:51], s41 offen offset:1024 sc1
    v_mfma_f32_32x32x16_bf16 v[32:47], a[100:103], v[220:223], v[32:47]
    s_waitcnt vmcnt(7)
    v_mfma_f32_32x32x16_bf16 v[48:63], a[192:195], v[224:227], v[48:63]
    buffer_load_dwordx4 v[96:99], v1, s[48:51], s41 offen offset:2048 sc1
    v_mfma_f32_32x32x16_bf16 v[32:47], a[104:107], v[224:227], v[32:47]
    s_waitcnt lgkmcnt(0)
    s_waitcnt vmcnt(7)
    v_mfma_f32_32x32x16_bf16 v[48:63], a[196:199], v[228:231], v[48:63]
    buffer_load_dwordx4 v[100:103], v1, s[48:51], s41 offen offset:3072 sc1
    v_pk_add_f32 v[64:65], v[64:65], v[80:81]
    v_mfma_f32_32x32x16_bf16 v[32:47], a[108:111], v[228:231], v[32:47]
    v_pk_add_f32 v[66:67], v[66:67], v[82:83]
    s_waitcnt vmcnt(7)
    v_mfma_f32_32x32x16_bf16 v[48:63], a[200:203], v[232:235], v[48:63]
    s_add_u32 s41, s41, 4096
    s_cmp_eq_u32 s58, 3
    s_cselect_b32 s41, 0x7f000000, s41
    buffer_load_dwordx4 v[104:107], v1, s[48:51], s41 offen sc1
    v_pk_add_f32 v[68:69], v[68:69], v[84:85]
    v_mfma_f32_32x32x16_bf16 v[32:47], a[112:115], v[232:235], v[32:47]
    v_pk_add_f32 v[70:71], v[70:71], v[86:87]
    s_waitcnt vmcnt(7)
    v_mfma_f32_32x32x16_bf16 v[48:63], a[204:207], v[236:239], v[48:63]
    buffer_load_dwordx4 v[108:111], v1, s[48:51], s41 offen offset:1024 sc1
    v_pk_add_f32 v[72:73], v[72:73], v[88:89]
    v_mfma_f32_32x32x16_bf16 v[32:47], a[116:119], v[236:239], v[32:47]
    v_pk_add_f32 v[74:75], v[74:75], v[90:91]
    s_waitcnt vmcnt(7)
    v_mfma_f32_32x32x16_bf16 v[48:63], a[208:211], v[240:243], v[48:63]
    v_pk_add_f32 v[76:77], v[76:77], v[92:93]
    v_mfma_f32_32x32x16_bf16 v[32:47], a[120:123], v[240:243], v[32:47]
    v_pk_add_f32 v[78:79], v[78:79], v[94:95]
    s_waitcnt vmcnt(6)
    v_mfma_f32_32x32x16_bf16 v[48:63], a[212:215], v[244:247], v[48:63]
    v_mfma_f32_32x32x16_bf16 v[32:47], a[124:127], v[244:247], v[32:47]
    s_waitcnt vmcnt(5)
    v_mfma_f32_32x32x16_bf16 v[48:63], a[216:219], v[248:251], v[48:63]
    v_mfma_f32_32x32x16_bf16 v[32:47], a[128:131], v[248:251], v[32:47]
    s_waitcnt vmcnt(4)
    v_mfma_f32_32x32x16_bf16 v[48:63], a[220:223], v[252:255], v[48:63]
    s_waitcnt vmcnt(3)
    v_mfma_f32_32x32x16_bf16 v[48:63], a[224:227], v[96:99], v[48:63]
    s_waitcnt vmcnt(2)
    v_mfma_f32_32x32x16_bf16 v[48:63], a[228:231], v[100:103], v[48:63]
    s_waitcnt vmcnt(1)
    v_mfma_f32_32x32x16_bf16 v[48:63], a[232:235], v[104:107], v[48:63]
    s_waitcnt vmcnt(0)
    v_mfma_f32_32x32x16_bf16 v[48:63], a[236:239], v[108:111], v[48:63]
    v_mfma_f32_32x32x16_bf16 v[32:47], a[132:135], v[252:255], v[32:47]
    v_mfma_f32_32x32x16_bf16 v[32:47], a[136:139], v[96:99], v[32:47]
    s_nop 9
    ds_write_b128 v8, v[48:51] offset:0
    v_mfma_f32_32x32x16_bf16 v[32:47], a[140:143], v[100:103], v[32:47]
    ds_write_b128 v8, v[52:55] offset:1024
    v_mfma_f32_32x32x16_bf16 v[32:47], a[144:147], v[104:107], v[32:47]
    ds_write_b128 v8, v[56:59] offset:2048
    v_mfma_f32_32x32x16_bf16 v[32:47], a[148:151], v[108:111], v[32:47]
    ds_write_b128 v8, v[60:63] offset:3072
    s_waitcnt lgkmcnt(0)
    s_barrier
    ds_read_b128 v[48:51], v7 offset:0
    ds_read_b128 v[52:55], v7 offset:1024
    ds_read_b128 v[56:59], v7 offset:2048
    ds_read_b128 v[60:63], v7 offset:3072
    s_nop 4
    v_pk_add_f32 v[32:33], v[32:33], v[64:65]
    v_pk_add_f32 v[34:35], v[34:35], v[66:67]
    s_nop 2
    v_pk_add_f32 v[36:37], v[36:37], v[68:69]
    v_pk_add_f32 v[38:39], v[38:39], v[70:71]
    v_pk_add_f32 v[40:41], v[40:41], v[72:73]
    v_pk_add_f32 v[42:43], v[42:43], v[74:75]
    v_pk_add_f32 v[44:45], v[44:45], v[76:77]
    v_pk_add_f32 v[46:47], v[46:47], v[78:79]
    s_waitcnt lgkmcnt(0)
    v_pk_add_f32 v[32:33], v[32:33], v[48:49]
    v_pk_add_f32 v[34:35], v[34:35], v[50:51]
    v_pk_add_f32 v[36:37], v[36:37], v[52:53]
    v_pk_add_f32 v[38:39], v[38:39], v[54:55]
    v_pk_add_f32 v[40:41], v[40:41], v[56:57]
    v_pk_add_f32 v[42:43], v[42:43], v[58:59]
    v_pk_add_f32 v[44:45], v[44:45], v[60:61]
    v_pk_add_f32 v[46:47], v[46:47], v[62:63]
    v_fmac_f32 v16, v112, v32
    v_fmac_f32 v17, v113, v33
    v_fmac_f32 v18, v114, v34
    v_fmac_f32 v19, v115, v35
    v_fmac_f32 v20, v116, v36
    v_fmac_f32 v21, v117, v37
    v_fmac_f32 v22, v118, v38
    v_fmac_f32 v23, v119, v39
    v_fmac_f32 v24, v120, v40
    v_fmac_f32 v25, v121, v41
    v_fmac_f32 v26, v122, v42
    v_fmac_f32 v27, v123, v43
    v_fmac_f32 v28, v124, v44
    v_fmac_f32 v29, v125, v45
    v_fmac_f32 v30, v126, v46
    v_fmac_f32 v31, v127, v47
    v_cvt_pk_bf16_f32 v80, v16, v17
    v_cvt_pk_bf16_f32 v81, v18, v19
    ds_write_b64 v4, v[80:81] offset:0
    v_cvt_pk_bf16_f32 v82, v20, v21
    v_cvt_pk_bf16_f32 v83, v22, v23
    ds_write_b64 v4, v[82:83] offset:16
    v_cvt_pk_bf16_f32 v84, v24, v25
    v_cvt_pk_bf16_f32 v85, v26, v27
    ds_write_b64 v4, v[84:85] offset:32
    v_cvt_pk_bf16_f32 v86, v28, v29
    v_cvt_pk_bf16_f32 v87, v30, v31
    ds_write_b64 v4, v[86:87] offset:48
    ds_read_b128 v[88:91], v14
    ds_read_b128 v[92:95], v14 offset:1024
    s_waitcnt lgkmcnt(1)
    buffer_store_dwordx4 v[88:91], v13, s[44:47], s95 offen
    s_waitcnt lgkmcnt(0)
    buffer_store_dwordx4 v[92:95], v13, s[44:47], s64 offen
L_end:
    s_endpgm
L_code_end:
.section .rodata,"a"
.p2align 6
.amdhsa_kernel adaLN_cond__sliding_block__dense_activation_silu__prompt_kernel
  .amdhsa_next_free_vgpr 512
  .amdhsa_next_free_sgpr 102
  .amdhsa_accum_offset 256
  .amdhsa_group_segment_fixed_size 0
  .amdhsa_kernarg_size 88
  .amdhsa_user_sgpr_count 2
  .amdhsa_user_sgpr_kernarg_segment_ptr 1
  .amdhsa_system_sgpr_workgroup_id_x 1
  .amdhsa_float_denorm_mode_32 3
.end_amdhsa_kernel
```
